```python
import torch

def _softmax(x, axis=-1):
    return torch.softmax(x, dim=axis)
def _gelu(x):
    return torch.nn.functional.gelu(x, approximate="tanh")
def _silu(x):
    return torch.nn.functional.silu(x)
def _sigmoid(x):
    return torch.sigmoid(x)
def _layernorm(x, axis=-1, eps=1e-5):
    m = x.mean(dim=axis, keepdim=True)
    v = x.var(dim=axis, keepdim=True, unbiased=False)
    return (x - m) / torch.sqrt(v + eps)
def _scatter_add(tgt, idx, src, axis=0):
    return tgt.clone().index_add_(axis, idx, src)
def _segment_sum(src, seg, n):
    out = torch.zeros((n,) + src.shape[1:], dtype=src.dtype)
    return out.index_add_(0, seg, src)
def _pad(x, pw):
    flat = tuple(v for pair in reversed(pw) for v in pair)
    return torch.nn.functional.pad(x, flat)

kernel_name = 'gated_mix__softmax_full_mha__mixer_s_mlp__prompt'

def setup_inputs():

    _w = (lambda a: (lambda t: t.to(torch.bfloat16) if t.is_floating_point() else t)(torch.as_tensor(a)))
    def _A_setup():
        B, S, D = 1, 2048, 512
        return {
            "x": _w((lambda *s: torch.randn(*s, dtype=torch.bfloat16) * 0.05)(B, S, D)),
            "wqkv": _w((lambda *s: torch.randn(*s, dtype=torch.bfloat16) * 1.6)(D, 3 * D)),
            "wo": _w((lambda *s: torch.randn(*s, dtype=torch.bfloat16) * 0.1)(D, D)),
        }
    _A_in = _A_setup()

    def _B_setup():
        B, S, D, F = 1, 2048, 512, 1376
        return {
            "x":  _w((lambda *s: torch.randn(*s, dtype=torch.bfloat16) * 0.05)(B, S, D)),
            "w1": _w((lambda *s: torch.randn(*s, dtype=torch.bfloat16) * 3.2)(D, D) * (D ** -0.5)),
            "w2": _w((lambda *s: torch.randn(*s, dtype=torch.bfloat16) * 3.2)(D, D) * (D ** -0.5)),
            "w3": _w((lambda *s: torch.randn(*s, dtype=torch.bfloat16) * 3.2)(D, F) * (D ** -0.5)),
            "w4": _w((lambda *s: torch.randn(*s, dtype=torch.bfloat16) * 1.6)(F, D) * (F ** -0.5)),
        }
    _B_in = _B_setup()

    return {
        "A_x": _A_in["x"],
        "A_wqkv": _A_in["wqkv"],
        "A_wo": _A_in["wo"],
        "B_x": _B_in["x"],
        "B_w1": _B_in["w1"],
        "B_w2": _B_in["w2"],
        "B_w3": _B_in["w3"],
        "B_w4": _B_in["w4"],
        "gate_w": _w((lambda *s: torch.randn(*s, dtype=torch.bfloat16) * 0.05)(512) * 16.0),
    }

def reference(A_x, A_wqkv, A_wo, B_x, B_w1, B_w2, B_w3, B_w4, gate_w):
    def _A_ref(x, wqkv, wo):
        B, S, D = x.shape
        H = 32; Dh = D // H
        qkv = (lambda x, *d: x.permute(*d))((x @ wqkv).reshape(B, S, 3, H, Dh), 2, 0, 3, 1, 4)
        q, k, v = qkv[0], qkv[1], qkv[2]
        scale = Dh ** -0.5
        scores = torch.einsum("bhqd,bhkd->bhqk", q, k) * scale
        p = _softmax(scores, axis=-1)
        o = torch.einsum("bhqk,bhkd->bhqd", p, v)
        return (lambda x, *d: x.permute(*d))(o, 0, 2, 1, 3).reshape(B, S, D) @ wo

    def _B_ref(x, w1, w2, w3, w4):
        B, S, D = x.shape
        h = _gelu(_layernorm(x, axis=-1) @ w1)
        c = D // 4
        g0 = _pad(h[:, :, 0*c:1*c], ((0, 0), (1, 0), (0, 0)))[:, :S, :]
        g1 = _pad(h[:, :, 1*c:2*c], ((0, 0), (0, 1), (0, 0)))[:, 1:, :]
        g2 = _pad(h[:, :, 2*c:3*c], ((0, 0), (2, 0), (0, 0)))[:, :S, :]
        g3 = _pad(h[:, :, 3*c:   ], ((0, 0), (0, 2), (0, 0)))[:, 2:, :]
        hs = torch.concatenate([g0, g1, g2, g3], axis=-1) @ w2
        x1 = x + hs
        h2 = _gelu(_layernorm(x1, axis=-1) @ w3) @ w4
        return x1 + h2

    x = A_x
    g = _sigmoid((x * gate_w).sum(-1, keepdims=True))
    a = _A_ref(x, A_wqkv, A_wo)
    b = _B_ref(x, B_w1, B_w2, B_w3, B_w4)
    return g * a + (1 - g) * b
```

```asm
; @launch kernel=k1_kernel grid=(256,1,1) block=(512,1,1) lds=133376
; @launch kernel=gated_mix__softmax_full_mha__mixer_s_mlp__prompt_kernel grid=(512,1,1) block=(512,1,1) lds=81920
.amdgcn_target "amdgcn-amd-amdhsa--gfx950"
.text
.globl k1_kernel
.p2align 8
.type k1_kernel,@function
k1_kernel:
    s_cmp_ge_u32 s2, 256
    s_cbranch_scc1 L_exit0
    s_load_dwordx4 s[36:39], s[0:1], 0
    s_load_dwordx2 s[40:41], s[0:1], 32
    s_load_dwordx2 s[42:43], s[0:1], 88
    s_load_dwordx2 s[56:57], s[0:1], 80
    s_load_dwordx2 s[58:59], s[0:1], 64
    s_getpc_b64 s[64:65]
K0_pc:
    s_lshr_b32 s24, s2, 3
    s_lshl_b32 s24, s24, 13
    v_lshl_add_u32 v148, v0, 4, s24
    s_sub_u32 s64, s64, K0_pc-k1_kernel
    s_subb_u32 s65, s65, 0
    v_min_u32 v148, L_text_end-k1_kernel-16, v148
    v_mov_b32 v149, s65
    v_add_co_u32 v148, vcc, s64, v148
    s_nop 1
    v_addc_co_u32 v149, vcc, 0, v149, vcc
    global_load_dwordx4 v[148:151], v[148:149], off
    v_lshrrev_b32 v2, 6, v0
    v_and_b32 v1, 63, v0
    v_readfirstlane_b32 s20, v2
    s_and_b32 s24, s2, 7
    s_lshr_b32 s25, s2, 3
    s_lshr_b32 s21, s24, 1
    s_lshl_b32 s21, s21, 2
    s_and_b32 s34, s25, 3
    s_add_u32 s21, s21, s34
    s_and_b32 s49, s24, 1
    s_lshr_b32 s44, s25, 2
    s_and_b32 s34, s20, 3
    s_cmp_lt_u32 s20, 4
    s_cbranch_scc1 K0_gemm
    v_lshrrev_b32 v2, 3, v1
    v_lshrrev_b32 v3, 4, v1
    v_and_b32 v4, 7, v1
    v_xor_b32 v5, v4, v3
    v_xor_b32 v6, 4, v5
    v_lshlrev_b32 v7, 10, v2
    v_lshl_add_u32 v5, v5, 4, v7
    v_lshl_add_u32 v6, v6, 4, v7
    v_add_u32 v6, 8192, v6
    v_and_b32 v3, 1, v3
    v_lshlrev_b32 v3, 2, v3
    v_xor_b32 v4, v4, v3
    s_lshl_b32 s26, s21, 7
    s_lshl_b32 s24, s34, 5
    s_add_u32 s26, s26, s24
    s_lshl_b32 s45, s26, 10
    s_lshl_b32 s30, s34, 12
    s_lshl_b32 s31, s34, 12
    s_add_u32 s31, s31, 65536
    s_lshr_b32 s24, s34, 1
    s_lshl_b32 s25, s49, 1
    s_add_u32 s25, s25, s24
    s_cmp_eq_u32 s25, 3
    s_mov_b32 s29, 3072
    s_cmov_b32 s29, 1024
    s_cselect_b32 s25, 0, s25
    s_lshl_b32 s25, s25, 10
    s_lshl_b32 s46, s44, 7
    s_add_u32 s46, s46, s25
    s_and_b32 s24, s34, 1
    s_lshl_b32 s24, s24, 5
    s_mul_i32 s24, s24, s29
    s_add_u32 s46, s46, s24
    s_lshl_b32 s28, s29, 6
    v_mul_lo_u32 v2, v2, s29
    v_lshl_add_u32 v7, v4, 4, v2
    s_lshl_b32 s25, s29, 3
    s_cmp_eq_u32 s29, 1024
    s_mov_b32 s29, s25
    s_waitcnt lgkmcnt(0)
    s_cselect_b32 s12, s40, s38
    s_cselect_b32 s13, s41, s39
    s_mov_b32 s14, 1572864
    s_cmov_b32 s14, 524288
    s_mov_b32 s15, 0x20000
    s_and_b32 s48, s21, 3
    s_lshl_b32 s48, s48, 1
    s_add_u32 s48, s48, s44
    s_and_b32 s48, s48, 7
    s_mov_b32 s8, s36
    s_mov_b32 s9, s37
    s_mov_b32 s10, 0x200000
    s_mov_b32 s11, 0x20000
    s_cmp_eq_u32 s49, 0
    s_cbranch_scc0 K0_norow
    s_mov_b32 s60, s58
    s_mov_b32 s61, s59
    s_mov_b32 s62, 0x400
    s_mov_b32 s63, 0x20000
    s_lshl_b32 s24, s21, 7
    s_lshl_b32 s25, s44, 4
    s_add_u32 s24, s24, s25
    s_lshl_b32 s25, s34, 2
    s_add_u32 s51, s24, s25
    s_lshl_b32 s24, s51, 10
    v_lshlrev_b32 v2, 4, v1
    buffer_load_dwordx4 v[20:23], v2, s[8:11], s24 offen
    buffer_load_dwordx4 v[24:27], v2, s[8:11], s24 offen offset:1024
    buffer_load_dwordx4 v[28:31], v2, s[8:11], s24 offen offset:2048
    buffer_load_dwordx4 v[32:35], v2, s[8:11], s24 offen offset:3072
    buffer_load_dwordx4 v[36:39], v2, s[60:63], 0 offen
K0_norow:
    s_mov_b32 s33, 0
    s_lshl_b32 s24, s48, 7
    s_add_u32 s26, s45, s24
    s_add_u32 s47, s26, 16384
    s_mul_i32 s24, s48, s28
    s_add_u32 s27, s46, s24
    s_add_u32 s48, s48, 1
    s_and_b32 s48, s48, 7
    s_add_u32 s24, s33, s30
    s_add_u32 s25, s33, s31
    s_add_u32 m0, s24, 0
    s_nop 0
    buffer_load_dwordx4 v5, s[8:11], s26 offen lds
    s_add_u32 m0, s25, 0
    s_nop 0
    buffer_load_dwordx4 v7, s[12:15], s27 offen lds
    s_add_u32 s27, s27, s29
    s_add_u32 m0, s24, 1024
    s_nop 0
    buffer_load_dwordx4 v6, s[8:11], s26 offen lds
    s_add_u32 m0, s25, 1024
    s_nop 0
    buffer_load_dwordx4 v7, s[12:15], s27 offen lds
    s_add_u32 s27, s27, s29
    s_add_u32 m0, s24, 2048
    s_nop 0
    buffer_load_dwordx4 v5, s[8:11], s47 offen lds
    s_add_u32 m0, s25, 2048
    s_nop 0
    buffer_load_dwordx4 v7, s[12:15], s27 offen lds
    s_add_u32 s27, s27, s29
    s_add_u32 m0, s24, 3072
    s_nop 0
    buffer_load_dwordx4 v6, s[8:11], s47 offen lds
    s_add_u32 m0, s25, 3072
    s_nop 0
    buffer_load_dwordx4 v7, s[12:15], s27 offen lds
    s_mov_b32 s33, 16384
    s_lshl_b32 s24, s48, 7
    s_add_u32 s26, s45, s24
    s_add_u32 s47, s26, 16384
    s_mul_i32 s24, s48, s28
    s_add_u32 s27, s46, s24
    s_add_u32 s48, s48, 1
    s_and_b32 s48, s48, 7
    s_add_u32 s24, s33, s30
    s_add_u32 s25, s33, s31
    s_add_u32 m0, s24, 0
    s_nop 0
    buffer_load_dwordx4 v5, s[8:11], s26 offen lds
    s_add_u32 m0, s25, 0
    s_nop 0
    buffer_load_dwordx4 v7, s[12:15], s27 offen lds
    s_add_u32 s27, s27, s29
    s_add_u32 m0, s24, 1024
    s_nop 0
    buffer_load_dwordx4 v6, s[8:11], s26 offen lds
    s_add_u32 m0, s25, 1024
    s_nop 0
    buffer_load_dwordx4 v7, s[12:15], s27 offen lds
    s_add_u32 s27, s27, s29
    s_add_u32 m0, s24, 2048
    s_nop 0
    buffer_load_dwordx4 v5, s[8:11], s47 offen lds
    s_add_u32 m0, s25, 2048
    s_nop 0
    buffer_load_dwordx4 v7, s[12:15], s27 offen lds
    s_add_u32 s27, s27, s29
    s_add_u32 m0, s24, 3072
    s_nop 0
    buffer_load_dwordx4 v6, s[8:11], s47 offen lds
    s_add_u32 m0, s25, 3072
    s_nop 0
    buffer_load_dwordx4 v7, s[12:15], s27 offen lds
    s_mov_b32 s33, 32768
    s_mov_b32 s32, 0
    s_mov_b32 s23, 0
    s_mov_b32 s16, s42
    s_mov_b32 s17, s43
    s_mov_b32 s18, 0x1600000
    s_mov_b32 s19, 0x20000
    s_cmp_eq_u32 s20, 5
    s_cbranch_scc0 K0_npad
    s_lshl_b32 s24, s2, 8
    s_cmp_ge_u32 s24, 32768
    s_cselect_b32 s25, 0x200000, 0
    s_add_u32 s24, s24, s25
    s_add_u32 s24, s24, 0x600000
    v_mov_b32 v12, 0
    v_mov_b32 v13, 0
    v_mov_b32 v14, 0
    v_mov_b32 v15, 0
    v_lshlrev_b32 v16, 4, v1
    s_mov_b64 exec, 0xffff
    buffer_store_dwordx4 v[12:15], v16, s[16:19], s24 offen
    s_mov_b64 exec, -1
K0_npad:
    s_cmp_eq_u32 s49, 0
    s_cbranch_scc0 K0_lb
    s_cmp_eq_u32 s2, 0
    s_cbranch_scc0 K0_nzf
    s_cmp_eq_u32 s20, 4
    s_cbranch_scc0 K0_nzf
    v_mov_b32 v12, 0
    v_mov_b32 v13, 0
    v_mov_b32 v14, 0
    v_mov_b32 v15, 0
    v_lshlrev_b32 v16, 4, v1
    s_mov_b32 s24, 0x1480000
    buffer_store_dwordx4 v[12:15], v16, s[16:19], s24 offen offset:0
    buffer_store_dwordx4 v[12:15], v16, s[16:19], s24 offen offset:1024
    buffer_store_dwordx4 v[12:15], v16, s[16:19], s24 offen offset:2048
    buffer_store_dwordx4 v[12:15], v16, s[16:19], s24 offen offset:3072
    s_add_u32 s24, s24, 4096
    s_nop 0
    buffer_store_dwordx4 v[12:15], v16, s[16:19], s24 offen offset:0
    buffer_store_dwordx4 v[12:15], v16, s[16:19], s24 offen offset:1024
    buffer_store_dwordx4 v[12:15], v16, s[16:19], s24 offen offset:2048
    buffer_store_dwordx4 v[12:15], v16, s[16:19], s24 offen offset:3072
    s_add_u32 s24, s24, 4096
    s_nop 0
    buffer_store_dwordx4 v[12:15], v16, s[16:19], s24 offen offset:0
    buffer_store_dwordx4 v[12:15], v16, s[16:19], s24 offen offset:1024
    buffer_store_dwordx4 v[12:15], v16, s[16:19], s24 offen offset:2048
    buffer_store_dwordx4 v[12:15], v16, s[16:19], s24 offen offset:3072
K0_nzf:
    s_mov_b32 s52, s56
    s_mov_b32 s53, s57
    s_mov_b32 s54, 0x100
    s_mov_b32 s55, 0x20000
    s_waitcnt vmcnt(16)
    v_lshlrev_b32 v40, 16, v36
    v_and_b32 v41, 0xffff0000, v36
    v_lshlrev_b32 v42, 16, v37
    v_and_b32 v43, 0xffff0000, v37
    v_lshlrev_b32 v44, 16, v38
    v_and_b32 v45, 0xffff0000, v38
    v_lshlrev_b32 v46, 16, v39
    v_and_b32 v47, 0xffff0000, v39
    v_lshlrev_b32 v60, 16, v20
    v_and_b32 v61, 0xffff0000, v20
    v_add_f32 v48, v60, v61
    v_mul_f32 v52, v60, v60
    v_mul_f32 v56, v60, v40
    v_fmac_f32 v52, v61, v61
    v_fmac_f32 v56, v61, v41
    v_lshlrev_b32 v60, 16, v21
    v_and_b32 v61, 0xffff0000, v21
    v_add_f32 v48, v48, v60
    v_fmac_f32 v52, v60, v60
    v_fmac_f32 v56, v60, v42
    v_add_f32 v48, v48, v61
    v_fmac_f32 v52, v61, v61
    v_fmac_f32 v56, v61, v43
    v_lshlrev_b32 v60, 16, v22
    v_and_b32 v61, 0xffff0000, v22
    v_add_f32 v48, v48, v60
    v_fmac_f32 v52, v60, v60
    v_fmac_f32 v56, v60, v44
    v_add_f32 v48, v48, v61
    v_fmac_f32 v52, v61, v61
    v_fmac_f32 v56, v61, v45
    v_lshlrev_b32 v60, 16, v23
    v_and_b32 v61, 0xffff0000, v23
    v_add_f32 v48, v48, v60
    v_fmac_f32 v52, v60, v60
    v_fmac_f32 v56, v60, v46
    v_add_f32 v48, v48, v61
    v_fmac_f32 v52, v61, v61
    v_fmac_f32 v56, v61, v47
    v_lshlrev_b32 v60, 16, v24
    v_and_b32 v61, 0xffff0000, v24
    v_add_f32 v49, v60, v61
    v_mul_f32 v53, v60, v60
    v_mul_f32 v57, v60, v40
    v_fmac_f32 v53, v61, v61
    v_fmac_f32 v57, v61, v41
    v_lshlrev_b32 v60, 16, v25
    v_and_b32 v61, 0xffff0000, v25
    v_add_f32 v49, v49, v60
    v_fmac_f32 v53, v60, v60
    v_fmac_f32 v57, v60, v42
    v_add_f32 v49, v49, v61
    v_fmac_f32 v53, v61, v61
    v_fmac_f32 v57, v61, v43
    v_lshlrev_b32 v60, 16, v26
    v_and_b32 v61, 0xffff0000, v26
    v_add_f32 v49, v49, v60
    v_fmac_f32 v53, v60, v60
    v_fmac_f32 v57, v60, v44
    v_add_f32 v49, v49, v61
    v_fmac_f32 v53, v61, v61
    v_fmac_f32 v57, v61, v45
    v_lshlrev_b32 v60, 16, v27
    v_and_b32 v61, 0xffff0000, v27
    v_add_f32 v49, v49, v60
    v_fmac_f32 v53, v60, v60
    v_fmac_f32 v57, v60, v46
    v_add_f32 v49, v49, v61
    v_fmac_f32 v53, v61, v61
    v_fmac_f32 v57, v61, v47
    v_lshlrev_b32 v60, 16, v28
    v_and_b32 v61, 0xffff0000, v28
    v_add_f32 v50, v60, v61
    v_mul_f32 v54, v60, v60
    v_mul_f32 v58, v60, v40
    v_fmac_f32 v54, v61, v61
    v_fmac_f32 v58, v61, v41
    v_lshlrev_b32 v60, 16, v29
    v_and_b32 v61, 0xffff0000, v29
    v_add_f32 v50, v50, v60
    v_fmac_f32 v54, v60, v60
    v_fmac_f32 v58, v60, v42
    v_add_f32 v50, v50, v61
    v_fmac_f32 v54, v61, v61
    v_fmac_f32 v58, v61, v43
    v_lshlrev_b32 v60, 16, v30
    v_and_b32 v61, 0xffff0000, v30
    v_add_f32 v50, v50, v60
    v_fmac_f32 v54, v60, v60
    v_fmac_f32 v58, v60, v44
    v_add_f32 v50, v50, v61
    v_fmac_f32 v54, v61, v61
    v_fmac_f32 v58, v61, v45
    v_lshlrev_b32 v60, 16, v31
    v_and_b32 v61, 0xffff0000, v31
    v_add_f32 v50, v50, v60
    v_fmac_f32 v54, v60, v60
    v_fmac_f32 v58, v60, v46
    v_add_f32 v50, v50, v61
    v_fmac_f32 v54, v61, v61
    v_fmac_f32 v58, v61, v47
    v_lshlrev_b32 v60, 16, v32
    v_and_b32 v61, 0xffff0000, v32
    v_add_f32 v51, v60, v61
    v_mul_f32 v55, v60, v60
    v_mul_f32 v59, v60, v40
    v_fmac_f32 v55, v61, v61
    v_fmac_f32 v59, v61, v41
    v_lshlrev_b32 v60, 16, v33
    v_and_b32 v61, 0xffff0000, v33
    v_add_f32 v51, v51, v60
    v_fmac_f32 v55, v60, v60
    v_fmac_f32 v59, v60, v42
    v_add_f32 v51, v51, v61
    v_fmac_f32 v55, v61, v61
    v_fmac_f32 v59, v61, v43
    v_lshlrev_b32 v60, 16, v34
    v_and_b32 v61, 0xffff0000, v34
    v_add_f32 v51, v51, v60
    v_fmac_f32 v55, v60, v60
    v_fmac_f32 v59, v60, v44
    v_add_f32 v51, v51, v61
    v_fmac_f32 v55, v61, v61
    v_fmac_f32 v59, v61, v45
    v_lshlrev_b32 v60, 16, v35
    v_and_b32 v61, 0xffff0000, v35
    v_add_f32 v51, v51, v60
    v_fmac_f32 v55, v60, v60
    v_fmac_f32 v59, v60, v46
    v_add_f32 v51, v51, v61
    v_fmac_f32 v55, v61, v61
    v_fmac_f32 v59, v61, v47
    s_nop 1
    v_add_f32_dpp v48, v48, v48 row_shr:1 row_mask:0xf bank_mask:0xf bound_ctrl:1
    v_add_f32_dpp v49, v49, v49 row_shr:1 row_mask:0xf bank_mask:0xf bound_ctrl:1
    v_add_f32_dpp v50, v50, v50 row_shr:1 row_mask:0xf bank_mask:0xf bound_ctrl:1
    v_add_f32_dpp v51, v51, v51 row_shr:1 row_mask:0xf bank_mask:0xf bound_ctrl:1
    v_add_f32_dpp v52, v52, v52 row_shr:1 row_mask:0xf bank_mask:0xf bound_ctrl:1
    v_add_f32_dpp v53, v53, v53 row_shr:1 row_mask:0xf bank_mask:0xf bound_ctrl:1
    v_add_f32_dpp v54, v54, v54 row_shr:1 row_mask:0xf bank_mask:0xf bound_ctrl:1
    v_add_f32_dpp v55, v55, v55 row_shr:1 row_mask:0xf bank_mask:0xf bound_ctrl:1
    v_add_f32_dpp v56, v56, v56 row_shr:1 row_mask:0xf bank_mask:0xf bound_ctrl:1
    v_add_f32_dpp v57, v57, v57 row_shr:1 row_mask:0xf bank_mask:0xf bound_ctrl:1
    v_add_f32_dpp v58, v58, v58 row_shr:1 row_mask:0xf bank_mask:0xf bound_ctrl:1
    v_add_f32_dpp v59, v59, v59 row_shr:1 row_mask:0xf bank_mask:0xf bound_ctrl:1
    v_add_f32_dpp v48, v48, v48 row_shr:2 row_mask:0xf bank_mask:0xf bound_ctrl:1
    v_add_f32_dpp v49, v49, v49 row_shr:2 row_mask:0xf bank_mask:0xf bound_ctrl:1
    v_add_f32_dpp v50, v50, v50 row_shr:2 row_mask:0xf bank_mask:0xf bound_ctrl:1
    v_add_f32_dpp v51, v51, v51 row_shr:2 row_mask:0xf bank_mask:0xf bound_ctrl:1
    v_add_f32_dpp v52, v52, v52 row_shr:2 row_mask:0xf bank_mask:0xf bound_ctrl:1
    v_add_f32_dpp v53, v53, v53 row_shr:2 row_mask:0xf bank_mask:0xf bound_ctrl:1
    v_add_f32_dpp v54, v54, v54 row_shr:2 row_mask:0xf bank_mask:0xf bound_ctrl:1
    v_add_f32_dpp v55, v55, v55 row_shr:2 row_mask:0xf bank_mask:0xf bound_ctrl:1
    v_add_f32_dpp v56, v56, v56 row_shr:2 row_mask:0xf bank_mask:0xf bound_ctrl:1
    v_add_f32_dpp v57, v57, v57 row_shr:2 row_mask:0xf bank_mask:0xf bound_ctrl:1
    v_add_f32_dpp v58, v58, v58 row_shr:2 row_mask:0xf bank_mask:0xf bound_ctrl:1
    v_add_f32_dpp v59, v59, v59 row_shr:2 row_mask:0xf bank_mask:0xf bound_ctrl:1
    v_add_f32_dpp v48, v48, v48 row_shr:4 row_mask:0xf bank_mask:0xf bound_ctrl:1
    v_add_f32_dpp v49, v49, v49 row_shr:4 row_mask:0xf bank_mask:0xf bound_ctrl:1
    v_add_f32_dpp v50, v50, v50 row_shr:4 row_mask:0xf bank_mask:0xf bound_ctrl:1
    v_add_f32_dpp v51, v51, v51 row_shr:4 row_mask:0xf bank_mask:0xf bound_ctrl:1
    v_add_f32_dpp v52, v52, v52 row_shr:4 row_mask:0xf bank_mask:0xf bound_ctrl:1
    v_add_f32_dpp v53, v53, v53 row_shr:4 row_mask:0xf bank_mask:0xf bound_ctrl:1
    v_add_f32_dpp v54, v54, v54 row_shr:4 row_mask:0xf bank_mask:0xf bound_ctrl:1
    v_add_f32_dpp v55, v55, v55 row_shr:4 row_mask:0xf bank_mask:0xf bound_ctrl:1
    v_add_f32_dpp v56, v56, v56 row_shr:4 row_mask:0xf bank_mask:0xf bound_ctrl:1
    v_add_f32_dpp v57, v57, v57 row_shr:4 row_mask:0xf bank_mask:0xf bound_ctrl:1
    v_add_f32_dpp v58, v58, v58 row_shr:4 row_mask:0xf bank_mask:0xf bound_ctrl:1
    v_add_f32_dpp v59, v59, v59 row_shr:4 row_mask:0xf bank_mask:0xf bound_ctrl:1
    v_add_f32_dpp v48, v48, v48 row_shr:8 row_mask:0xf bank_mask:0xf bound_ctrl:1
    v_add_f32_dpp v49, v49, v49 row_shr:8 row_mask:0xf bank_mask:0xf bound_ctrl:1
    v_add_f32_dpp v50, v50, v50 row_shr:8 row_mask:0xf bank_mask:0xf bound_ctrl:1
    v_add_f32_dpp v51, v51, v51 row_shr:8 row_mask:0xf bank_mask:0xf bound_ctrl:1
    v_add_f32_dpp v52, v52, v52 row_shr:8 row_mask:0xf bank_mask:0xf bound_ctrl:1
    v_add_f32_dpp v53, v53, v53 row_shr:8 row_mask:0xf bank_mask:0xf bound_ctrl:1
    v_add_f32_dpp v54, v54, v54 row_shr:8 row_mask:0xf bank_mask:0xf bound_ctrl:1
    v_add_f32_dpp v55, v55, v55 row_shr:8 row_mask:0xf bank_mask:0xf bound_ctrl:1
    v_add_f32_dpp v56, v56, v56 row_shr:8 row_mask:0xf bank_mask:0xf bound_ctrl:1
    v_add_f32_dpp v57, v57, v57 row_shr:8 row_mask:0xf bank_mask:0xf bound_ctrl:1
    v_add_f32_dpp v58, v58, v58 row_shr:8 row_mask:0xf bank_mask:0xf bound_ctrl:1
    v_add_f32_dpp v59, v59, v59 row_shr:8 row_mask:0xf bank_mask:0xf bound_ctrl:1
    v_add_f32_dpp v48, v48, v48 row_bcast:15 row_mask:0xa bank_mask:0xf
    v_add_f32_dpp v49, v49, v49 row_bcast:15 row_mask:0xa bank_mask:0xf
    v_add_f32_dpp v50, v50, v50 row_bcast:15 row_mask:0xa bank_mask:0xf
    v_add_f32_dpp v51, v51, v51 row_bcast:15 row_mask:0xa bank_mask:0xf
    v_add_f32_dpp v52, v52, v52 row_bcast:15 row_mask:0xa bank_mask:0xf
    v_add_f32_dpp v53, v53, v53 row_bcast:15 row_mask:0xa bank_mask:0xf
    v_add_f32_dpp v54, v54, v54 row_bcast:15 row_mask:0xa bank_mask:0xf
    v_add_f32_dpp v55, v55, v55 row_bcast:15 row_mask:0xa bank_mask:0xf
    v_add_f32_dpp v56, v56, v56 row_bcast:15 row_mask:0xa bank_mask:0xf
    v_add_f32_dpp v57, v57, v57 row_bcast:15 row_mask:0xa bank_mask:0xf
    v_add_f32_dpp v58, v58, v58 row_bcast:15 row_mask:0xa bank_mask:0xf
    v_add_f32_dpp v59, v59, v59 row_bcast:15 row_mask:0xa bank_mask:0xf
    v_add_f32_dpp v48, v48, v48 row_bcast:31 row_mask:0xc bank_mask:0xf
    v_add_f32_dpp v49, v49, v49 row_bcast:31 row_mask:0xc bank_mask:0xf
    v_add_f32_dpp v50, v50, v50 row_bcast:31 row_mask:0xc bank_mask:0xf
    v_add_f32_dpp v51, v51, v51 row_bcast:31 row_mask:0xc bank_mask:0xf
    v_add_f32_dpp v52, v52, v52 row_bcast:31 row_mask:0xc bank_mask:0xf
    v_add_f32_dpp v53, v53, v53 row_bcast:31 row_mask:0xc bank_mask:0xf
    v_add_f32_dpp v54, v54, v54 row_bcast:31 row_mask:0xc bank_mask:0xf
    v_add_f32_dpp v55, v55, v55 row_bcast:31 row_mask:0xc bank_mask:0xf
    v_add_f32_dpp v56, v56, v56 row_bcast:31 row_mask:0xc bank_mask:0xf
    v_add_f32_dpp v57, v57, v57 row_bcast:31 row_mask:0xc bank_mask:0xf
    v_add_f32_dpp v58, v58, v58 row_bcast:31 row_mask:0xc bank_mask:0xf
    v_add_f32_dpp v59, v59, v59 row_bcast:31 row_mask:0xc bank_mask:0xf
    s_nop 1
    v_mul_f32 v48, 0x3b000000, v48
    v_mul_f32 v52, 0x3b000000, v52
    v_mul_f32 v56, 0xbfb8aa3b, v56
    v_mul_f32 v49, 0x3b000000, v49
    v_mul_f32 v53, 0x3b000000, v53
    v_mul_f32 v57, 0xbfb8aa3b, v57
    v_mul_f32 v50, 0x3b000000, v50
    v_mul_f32 v54, 0x3b000000, v54
    v_mul_f32 v58, 0xbfb8aa3b, v58
    v_mul_f32 v51, 0x3b000000, v51
    v_mul_f32 v55, 0x3b000000, v55
    v_mul_f32 v59, 0xbfb8aa3b, v59
    v_fma_f32 v52, -v48, v48, v52
    v_exp_f32 v56, v56
    v_fma_f32 v53, -v49, v49, v53
    v_exp_f32 v57, v57
    v_fma_f32 v54, -v50, v50, v54
    v_exp_f32 v58, v58
    v_fma_f32 v55, -v51, v51, v55
    v_exp_f32 v59, v59
    v_max_f32 v52, 0, v52
    v_add_f32 v56, 1.0, v56
    v_max_f32 v53, 0, v53
    v_add_f32 v57, 1.0, v57
    v_max_f32 v54, 0, v54
    v_add_f32 v58, 1.0, v58
    v_max_f32 v55, 0, v55
    v_add_f32 v59, 1.0, v59
    v_add_f32 v52, 0x3727c5ac, v52
    v_rcp_f32 v56, v56
    v_add_f32 v53, 0x3727c5ac, v53
    v_rcp_f32 v57, v57
    v_add_f32 v54, 0x3727c5ac, v54
    v_rcp_f32 v58, v58
    v_add_f32 v55, 0x3727c5ac, v55
    v_rcp_f32 v59, v59
    v_rsq_f32 v60, v52
    v_rsq_f32 v62, v53
    v_rsq_f32 v64, v54
    v_rsq_f32 v66, v55
    s_nop 0
    v_mul_f32 v61, v48, v60
    v_mul_f32 v63, v49, v62
    v_mul_f32 v65, v50, v64
    v_mul_f32 v67, v51, v66
    v_sub_f32 v61, 0, v61
    v_sub_f32 v63, 0, v63
    v_sub_f32 v65, 0, v65
    v_sub_f32 v67, 0, v67
    s_lshl_b32 s61, s51, 3
    s_add_u32 s61, s61, 0x1460000
    s_lshl_b32 s62, s51, 2
    s_add_u32 s62, s62, 0x1468000
    v_mov_b32 v2, 0
    s_mov_b32 exec_lo, 0
    s_mov_b32 exec_hi, 0x80000000
    buffer_store_dwordx4 v[60:63], v2, s[16:19], s61 offen sc1
    buffer_store_dwordx4 v[64:67], v2, s[16:19], s61 offen offset:16 sc1
    buffer_store_dwordx4 v[56:59], v2, s[16:19], s62 offen sc1
    s_mov_b64 exec, -1
    s_waitcnt vmcnt(11)
    s_barrier
    s_lshl_b32 s24, s48, 7
    s_add_u32 s26, s45, s24
    s_add_u32 s47, s26, 16384
    s_mul_i32 s24, s48, s28
    s_add_u32 s27, s46, s24
    s_add_u32 s48, s48, 1
    s_and_b32 s48, s48, 7
    s_add_u32 s24, s33, s30
    s_add_u32 s25, s33, s31
    s_add_u32 m0, s24, 0
    s_nop 0
    buffer_load_dwordx4 v5, s[8:11], s26 offen lds
    s_add_u32 m0, s25, 0
    s_nop 0
    buffer_load_dwordx4 v7, s[12:15], s27 offen lds
    s_add_u32 s27, s27, s29
    s_add_u32 m0, s24, 1024
    s_nop 0
    buffer_load_dwordx4 v6, s[8:11], s26 offen lds
    s_add_u32 m0, s25, 1024
    s_nop 0
    buffer_load_dwordx4 v7, s[12:15], s27 offen lds
    s_add_u32 s27, s27, s29
    s_add_u32 m0, s24, 2048
    s_nop 0
    buffer_load_dwordx4 v5, s[8:11], s47 offen lds
    s_add_u32 m0, s25, 2048
    s_nop 0
    buffer_load_dwordx4 v7, s[12:15], s27 offen lds
    s_add_u32 s27, s27, s29
    s_add_u32 m0, s24, 3072
    s_nop 0
    buffer_load_dwordx4 v6, s[8:11], s47 offen lds
    s_add_u32 m0, s25, 3072
    s_nop 0
    buffer_load_dwordx4 v7, s[12:15], s27 offen lds
    s_add_u32 s33, s33, 16384
    s_and_b32 s33, s33, 0xffff
    s_lshl_b32 s24, s48, 7
    s_add_u32 s26, s45, s24
    s_add_u32 s47, s26, 16384
    s_mul_i32 s24, s48, s28
    s_add_u32 s27, s46, s24
    s_add_u32 s48, s48, 1
    s_and_b32 s48, s48, 7
    s_add_u32 s24, s33, s30
    s_add_u32 s25, s33, s31
    s_add_u32 m0, s24, 0
    s_nop 0
    buffer_load_dwordx4 v5, s[8:11], s26 offen lds
    s_add_u32 m0, s25, 0
    s_nop 0
    buffer_load_dwordx4 v7, s[12:15], s27 offen lds
    s_add_u32 s27, s27, s29
    s_add_u32 m0, s24, 1024
    s_nop 0
    buffer_load_dwordx4 v6, s[8:11], s26 offen lds
    s_add_u32 m0, s25, 1024
    s_nop 0
    buffer_load_dwordx4 v7, s[12:15], s27 offen lds
    s_add_u32 s27, s27, s29
    s_add_u32 m0, s24, 2048
    s_nop 0
    buffer_load_dwordx4 v5, s[8:11], s47 offen lds
    s_add_u32 m0, s25, 2048
    s_nop 0
    buffer_load_dwordx4 v7, s[12:15], s27 offen lds
    s_add_u32 s27, s27, s29
    s_add_u32 m0, s24, 3072
    s_nop 0
    buffer_load_dwordx4 v6, s[8:11], s47 offen lds
    s_add_u32 m0, s25, 3072
    s_nop 0
    buffer_load_dwordx4 v7, s[12:15], s27 offen lds
    s_add_u32 s33, s33, 16384
    s_and_b32 s33, s33, 0xffff
    s_waitcnt vmcnt(16)
    s_barrier
    s_lshl_b32 s24, s48, 7
    s_add_u32 s26, s45, s24
    s_add_u32 s47, s26, 16384
    s_mul_i32 s24, s48, s28
    s_add_u32 s27, s46, s24
    s_add_u32 s48, s48, 1
    s_and_b32 s48, s48, 7
    s_add_u32 s24, s33, s30
    s_add_u32 s25, s33, s31
    s_add_u32 m0, s24, 0
    s_nop 0
    buffer_load_dwordx4 v5, s[8:11], s26 offen lds
    s_add_u32 m0, s25, 0
    s_nop 0
    buffer_load_dwordx4 v7, s[12:15], s27 offen lds
    s_add_u32 s27, s27, s29
    s_add_u32 m0, s24, 1024
    s_nop 0
    buffer_load_dwordx4 v6, s[8:11], s26 offen lds
    s_add_u32 m0, s25, 1024
    s_nop 0
    buffer_load_dwordx4 v7, s[12:15], s27 offen lds
    s_add_u32 s27, s27, s29
    s_add_u32 m0, s24, 2048
    s_nop 0
    buffer_load_dwordx4 v5, s[8:11], s47 offen lds
    s_add_u32 m0, s25, 2048
    s_nop 0
    buffer_load_dwordx4 v7, s[12:15], s27 offen lds
    s_add_u32 s27, s27, s29
    s_add_u32 m0, s24, 3072
    s_nop 0
    buffer_load_dwordx4 v6, s[8:11], s47 offen lds
    s_add_u32 m0, s25, 3072
    s_nop 0
    buffer_load_dwordx4 v7, s[12:15], s27 offen lds
    s_add_u32 s33, s33, 16384
    s_and_b32 s33, s33, 0xffff
    s_cmp_eq_u32 s20, 4
    s_cbranch_scc0 K0_la_nf
    s_lshl_b32 s24, s21, 4
    s_add_u32 s24, s24, s44
    v_mov_b32 v2, 0
    v_mov_b32 v3, 1
    s_mov_b64 exec, 1
    buffer_store_byte v3, v2, s[52:55], s24 offen sc1
    s_mov_b64 exec, -1
K0_la_nf:
    s_waitcnt vmcnt(16)
    s_barrier
    s_lshl_b32 s24, s48, 7
    s_add_u32 s26, s45, s24
    s_add_u32 s47, s26, 16384
    s_mul_i32 s24, s48, s28
    s_add_u32 s27, s46, s24
    s_add_u32 s48, s48, 1
    s_and_b32 s48, s48, 7
    s_add_u32 s24, s33, s30
    s_add_u32 s25, s33, s31
    s_add_u32 m0, s24, 0
    s_nop 0
    buffer_load_dwordx4 v5, s[8:11], s26 offen lds
    s_add_u32 m0, s25, 0
    s_nop 0
    buffer_load_dwordx4 v7, s[12:15], s27 offen lds
    s_add_u32 s27, s27, s29
    s_add_u32 m0, s24, 1024
    s_nop 0
    buffer_load_dwordx4 v6, s[8:11], s26 offen lds
    s_add_u32 m0, s25, 1024
    s_nop 0
    buffer_load_dwordx4 v7, s[12:15], s27 offen lds
    s_add_u32 s27, s27, s29
    s_add_u32 m0, s24, 2048
    s_nop 0
    buffer_load_dwordx4 v5, s[8:11], s47 offen lds
    s_add_u32 m0, s25, 2048
    s_nop 0
    buffer_load_dwordx4 v7, s[12:15], s27 offen lds
    s_add_u32 s27, s27, s29
    s_add_u32 m0, s24, 3072
    s_nop 0
    buffer_load_dwordx4 v6, s[8:11], s47 offen lds
    s_add_u32 m0, s25, 3072
    s_nop 0
    buffer_load_dwordx4 v7, s[12:15], s27 offen lds
    s_add_u32 s33, s33, 16384
    s_and_b32 s33, s33, 0xffff
    s_waitcnt vmcnt(16)
    s_barrier
    s_lshl_b32 s24, s48, 7
    s_add_u32 s26, s45, s24
    s_add_u32 s47, s26, 16384
    s_mul_i32 s24, s48, s28
    s_add_u32 s27, s46, s24
    s_add_u32 s48, s48, 1
    s_and_b32 s48, s48, 7
    s_add_u32 s24, s33, s30
    s_add_u32 s25, s33, s31
    s_add_u32 m0, s24, 0
    s_nop 0
    buffer_load_dwordx4 v5, s[8:11], s26 offen lds
    s_add_u32 m0, s25, 0
    s_nop 0
    buffer_load_dwordx4 v7, s[12:15], s27 offen lds
    s_add_u32 s27, s27, s29
    s_add_u32 m0, s24, 1024
    s_nop 0
    buffer_load_dwordx4 v6, s[8:11], s26 offen lds
    s_add_u32 m0, s25, 1024
    s_nop 0
    buffer_load_dwordx4 v7, s[12:15], s27 offen lds
    s_add_u32 s27, s27, s29
    s_add_u32 m0, s24, 2048
    s_nop 0
    buffer_load_dwordx4 v5, s[8:11], s47 offen lds
    s_add_u32 m0, s25, 2048
    s_nop 0
    buffer_load_dwordx4 v7, s[12:15], s27 offen lds
    s_add_u32 s27, s27, s29
    s_add_u32 m0, s24, 3072
    s_nop 0
    buffer_load_dwordx4 v6, s[8:11], s47 offen lds
    s_add_u32 m0, s25, 3072
    s_nop 0
    buffer_load_dwordx4 v7, s[12:15], s27 offen lds
    s_add_u32 s33, s33, 16384
    s_and_b32 s33, s33, 0xffff
    s_waitcnt vmcnt(16)
    s_barrier
    s_lshl_b32 s24, s48, 7
    s_add_u32 s26, s45, s24
    s_add_u32 s47, s26, 16384
    s_mul_i32 s24, s48, s28
    s_add_u32 s27, s46, s24
    s_add_u32 s48, s48, 1
    s_and_b32 s48, s48, 7
    s_add_u32 s24, s33, s30
    s_add_u32 s25, s33, s31
    s_add_u32 m0, s24, 0
    s_nop 0
    buffer_load_dwordx4 v5, s[8:11], s26 offen lds
    s_add_u32 m0, s25, 0
    s_nop 0
    buffer_load_dwordx4 v7, s[12:15], s27 offen lds
    s_add_u32 s27, s27, s29
    s_add_u32 m0, s24, 1024
    s_nop 0
    buffer_load_dwordx4 v6, s[8:11], s26 offen lds
    s_add_u32 m0, s25, 1024
    s_nop 0
    buffer_load_dwordx4 v7, s[12:15], s27 offen lds
    s_add_u32 s27, s27, s29
    s_add_u32 m0, s24, 2048
    s_nop 0
    buffer_load_dwordx4 v5, s[8:11], s47 offen lds
    s_add_u32 m0, s25, 2048
    s_nop 0
    buffer_load_dwordx4 v7, s[12:15], s27 offen lds
    s_add_u32 s27, s27, s29
    s_add_u32 m0, s24, 3072
    s_nop 0
    buffer_load_dwordx4 v6, s[8:11], s47 offen lds
    s_add_u32 m0, s25, 3072
    s_nop 0
    buffer_load_dwordx4 v7, s[12:15], s27 offen lds
    s_add_u32 s33, s33, 16384
    s_and_b32 s33, s33, 0xffff
    s_load_dwordx2 s[64:65], s[0:1], 40
    s_load_dwordx2 s[66:67], s[0:1], 48
    s_load_dwordx2 s[68:69], s[0:1], 56
    s_load_dwordx2 s[70:71], s[0:1], 16
    s_lshl_b32 s72, s21, 3
    s_add_u32 s72, s72, s44
    s_lshl_b32 s72, s72, 2
    s_add_u32 s72, s72, s34
    s_lshl_b32 s72, s72, 10
    v_lshlrev_b32 v12, 4, v1
    s_waitcnt lgkmcnt(0)
    s_mov_b32 s76, s64
    s_mov_b32 s77, s65
    s_mov_b32 s78, 524288
    s_mov_b32 s79, 0x20000
    s_mov_b32 s73, s72
    buffer_load_dwordx4 v[16:19], v12, s[76:79], s73 offen
    s_mov_b32 s76, s66
    s_mov_b32 s77, s67
    s_mov_b32 s78, 1409024
    s_mov_b32 s79, 0x20000
    s_mov_b32 s73, s72
    buffer_load_dwordx4 v[16:19], v12, s[76:79], s73 offen
    s_add_u32 s73, s73, 0x80000
    buffer_load_dwordx4 v[16:19], v12, s[76:79], s73 offen
    s_add_u32 s73, s73, 0x80000
    buffer_load_dwordx4 v[16:19], v12, s[76:79], s73 offen
    s_mov_b32 s76, s68
    s_mov_b32 s77, s69
    s_mov_b32 s78, 1409024
    s_mov_b32 s79, 0x20000
    s_mov_b32 s73, s72
    buffer_load_dwordx4 v[16:19], v12, s[76:79], s73 offen
    s_add_u32 s73, s73, 0x80000
    buffer_load_dwordx4 v[16:19], v12, s[76:79], s73 offen
    s_add_u32 s73, s73, 0x80000
    buffer_load_dwordx4 v[16:19], v12, s[76:79], s73 offen
    s_mov_b32 s76, s70
    s_mov_b32 s77, s71
    s_mov_b32 s78, 524288
    s_mov_b32 s79, 0x20000
    s_mov_b32 s73, s72
    buffer_load_dwordx4 v[16:19], v12, s[76:79], s73 offen
    s_waitcnt vmcnt(24)
    s_barrier
    s_waitcnt vmcnt(16)
    s_barrier
    s_waitcnt vmcnt(8)
    s_barrier
    s_endpgm
K0_lb:
    v_lshrrev_b32 v3, 5, v1
    v_lshlrev_b32 v2, 10, v3
    v_bfe_u32 v3, v1, 2, 2
    v_lshl_add_u32 v2, v3, 7, v2
    v_bfe_u32 v4, v1, 4, 1
    v_lshl_add_u32 v2, v4, 5, v2
    v_and_b32 v4, 3, v1
    v_lshl_add_u32 v2, v4, 3, v2
    v_add_u32 v2, 73728, v2
    v_lshrrev_b32 v3, 1, v3
    v_xor_b32 v4, 0, v3
    v_lshl_add_u32 v10, v4, 6, v2
    v_xor_b32 v4, 1, v3
    v_lshl_add_u32 v11, v4, 6, v2
    v_mov_b32 v24, 0
    v_mov_b32 v25, 0
    v_mov_b32 v26, 0
    v_mov_b32 v27, 0
    s_mov_b32 s52, s56
    s_mov_b32 s53, s57
    s_mov_b32 s54, 0x100
    s_mov_b32 s55, 0x20000
    s_lshl_b32 s60, s21, 4
    v_mov_b32 v30, 0
    s_lshl_b32 s62, s21, 10
    s_add_u32 s62, s62, 0x1460000
    v_lshlrev_b32 v34, 4, v1
    s_mov_b32 s63, 0
    s_waitcnt vmcnt(8) lgkmcnt(0)
    s_barrier
    s_lshl_b32 s24, s48, 7
    s_add_u32 s26, s45, s24
    s_add_u32 s47, s26, 16384
    s_mul_i32 s24, s48, s28
    s_add_u32 s27, s46, s24
    s_add_u32 s48, s48, 1
    s_and_b32 s48, s48, 7
    s_add_u32 s24, s33, s30
    s_add_u32 s25, s33, s31
    s_add_u32 m0, s24, 0
    s_nop 0
    buffer_load_dwordx4 v5, s[8:11], s26 offen lds
    s_add_u32 m0, s25, 0
    s_nop 0
    buffer_load_dwordx4 v7, s[12:15], s27 offen lds
    s_add_u32 s27, s27, s29
    s_add_u32 m0, s24, 1024
    s_nop 0
    buffer_load_dwordx4 v6, s[8:11], s26 offen lds
    s_add_u32 m0, s25, 1024
    s_nop 0
    buffer_load_dwordx4 v7, s[12:15], s27 offen lds
    s_add_u32 s27, s27, s29
    s_add_u32 m0, s24, 2048
    s_nop 0
    buffer_load_dwordx4 v5, s[8:11], s47 offen lds
    s_add_u32 m0, s25, 2048
    s_nop 0
    buffer_load_dwordx4 v7, s[12:15], s27 offen lds
    s_add_u32 s27, s27, s29
    s_add_u32 m0, s24, 3072
    s_nop 0
    buffer_load_dwordx4 v6, s[8:11], s47 offen lds
    s_add_u32 m0, s25, 3072
    s_nop 0
    buffer_load_dwordx4 v7, s[12:15], s27 offen lds
    s_add_u32 s33, s33, 16384
    s_branch K0_sl0
K0_sl:
    s_cmp_lt_u32 s23, 6
    s_cbranch_scc1 K0_s_w8
    s_cmp_eq_u32 s23, 6
    s_cbranch_scc1 K0_s_w4
    s_waitcnt vmcnt(0)
    s_branch K0_s_wd
K0_s_w4:
    s_waitcnt vmcnt(8)
    s_branch K0_s_wd
K0_s_w8:
    s_waitcnt vmcnt(16)
K0_s_wd:
    s_waitcnt lgkmcnt(0)
    s_barrier
K0_sl0:
    s_lshl_b32 s24, s34, 11
    s_add_u32 s24, s24, s32
    v_add_u32 v54, s24, v10
    ds_read_b64_tr_b16 v[44:45], v54
    ds_read_b64_tr_b16 v[46:47], v54 offset:512
    v_add_u32 v54, s24, v11
    ds_read_b64_tr_b16 v[48:49], v54
    ds_read_b64_tr_b16 v[50:51], v54 offset:512
    s_cmp_ge_u32 s23, 5
    s_cbranch_scc1 K0_s_nd
    s_lshl_b32 s24, s48, 7
    s_add_u32 s26, s45, s24
    s_add_u32 s47, s26, 16384
    s_mul_i32 s24, s48, s28
    s_add_u32 s27, s46, s24
    s_add_u32 s48, s48, 1
    s_and_b32 s48, s48, 7
    s_add_u32 s24, s33, s30
    s_add_u32 s25, s33, s31
    s_add_u32 m0, s24, 0
    s_nop 0
    buffer_load_dwordx4 v5, s[8:11], s26 offen lds
    s_waitcnt lgkmcnt(0)
    v_lshlrev_b32 v52, 16, v44
    v_and_b32 v53, 0xffff0000, v44
    v_add_f32 v24, v24, v52
    s_add_u32 m0, s25, 0
    s_nop 0
    buffer_load_dwordx4 v7, s[12:15], s27 offen lds
    s_add_u32 s27, s27, s29
    v_add_f32 v25, v25, v53
    v_lshlrev_b32 v52, 16, v45
    v_and_b32 v53, 0xffff0000, v45
    v_add_f32 v24, v24, v52
    s_add_u32 m0, s24, 1024
    s_nop 0
    buffer_load_dwordx4 v6, s[8:11], s26 offen lds
    v_add_f32 v25, v25, v53
    v_lshlrev_b32 v52, 16, v46
    v_and_b32 v53, 0xffff0000, v46
    v_add_f32 v24, v24, v52
    s_add_u32 m0, s25, 1024
    s_nop 0
    buffer_load_dwordx4 v7, s[12:15], s27 offen lds
    s_add_u32 s27, s27, s29
    v_add_f32 v25, v25, v53
    v_lshlrev_b32 v52, 16, v47
    v_and_b32 v53, 0xffff0000, v47
    v_add_f32 v24, v24, v52
    s_add_u32 m0, s24, 2048
    s_nop 0
    buffer_load_dwordx4 v5, s[8:11], s47 offen lds
    v_add_f32 v25, v25, v53
    v_lshlrev_b32 v52, 16, v48
    v_and_b32 v53, 0xffff0000, v48
    v_add_f32 v26, v26, v52
    s_add_u32 m0, s25, 2048
    s_nop 0
    buffer_load_dwordx4 v7, s[12:15], s27 offen lds
    s_add_u32 s27, s27, s29
    v_add_f32 v27, v27, v53
    v_lshlrev_b32 v52, 16, v49
    v_and_b32 v53, 0xffff0000, v49
    v_add_f32 v26, v26, v52
    s_add_u32 m0, s24, 3072
    s_nop 0
    buffer_load_dwordx4 v6, s[8:11], s47 offen lds
    v_add_f32 v27, v27, v53
    v_lshlrev_b32 v52, 16, v50
    v_and_b32 v53, 0xffff0000, v50
    v_add_f32 v26, v26, v52
    s_add_u32 m0, s25, 3072
    s_nop 0
    buffer_load_dwordx4 v7, s[12:15], s27 offen lds
    v_add_f32 v27, v27, v53
    v_lshlrev_b32 v52, 16, v51
    v_and_b32 v53, 0xffff0000, v51
    v_add_f32 v26, v26, v52
    v_add_f32 v27, v27, v53
    s_add_u32 s33, s33, 16384
    s_and_b32 s33, s33, 0xffff
    s_branch K0_s_nx
K0_s_nd:
    s_cmp_eq_u32 s23, 6
    s_cbranch_scc0 K0_s_nf
    s_cmp_eq_u32 s20, 4
    s_cbranch_scc0 K0_s_nf
    buffer_load_dwordx2 v[32:33], v30, s[52:55], s60 offen sc1
K0_s_nf:
    s_cmp_eq_u32 s23, 7
    s_cbranch_scc0 K0_s_ng
    s_cmp_eq_u32 s20, 4
    s_cbranch_scc0 K0_s_ng
    s_waitcnt vmcnt(0)
    v_and_b32 v32, v32, v33
    s_nop 0
    v_readfirstlane_b32 s24, v32
    s_cmp_eq_u32 s24, 0x01010101
    s_cbranch_scc0 K0_s_ng
    s_mov_b32 s63, 1
    buffer_load_dwordx4 v[28:31], v34, s[16:19], s62 offen sc1
K0_s_ng:
    s_waitcnt lgkmcnt(0)
    v_lshlrev_b32 v52, 16, v44
    v_and_b32 v53, 0xffff0000, v44
    v_add_f32 v24, v24, v52
    v_add_f32 v25, v25, v53
    v_lshlrev_b32 v52, 16, v45
    v_and_b32 v53, 0xffff0000, v45
    v_add_f32 v24, v24, v52
    v_add_f32 v25, v25, v53
    v_lshlrev_b32 v52, 16, v46
    v_and_b32 v53, 0xffff0000, v46
    v_add_f32 v24, v24, v52
    v_add_f32 v25, v25, v53
    v_lshlrev_b32 v52, 16, v47
    v_and_b32 v53, 0xffff0000, v47
    v_add_f32 v24, v24, v52
    v_add_f32 v25, v25, v53
    v_lshlrev_b32 v52, 16, v48
    v_and_b32 v53, 0xffff0000, v48
    v_add_f32 v26, v26, v52
    v_add_f32 v27, v27, v53
    v_lshlrev_b32 v52, 16, v49
    v_and_b32 v53, 0xffff0000, v49
    v_add_f32 v26, v26, v52
    v_add_f32 v27, v27, v53
    v_lshlrev_b32 v52, 16, v50
    v_and_b32 v53, 0xffff0000, v50
    v_add_f32 v26, v26, v52
    v_add_f32 v27, v27, v53
    v_lshlrev_b32 v52, 16, v51
    v_and_b32 v53, 0xffff0000, v51
    v_add_f32 v26, v26, v52
    v_add_f32 v27, v27, v53
K0_s_nx:
    s_add_u32 s32, s32, 16384
    s_and_b32 s32, s32, 0xffff
    s_add_u32 s23, s23, 1
    s_cmp_lt_u32 s23, 8
    s_cbranch_scc1 K0_sl
    v_add_f32 v24, v24, v25
    v_add_f32 v26, v26, v27
    v_lshlrev_b32 v55, 2, v1
    s_lshl_b32 s24, s34, 8
    s_add_u32 s24, s24, 132352
    v_permlane32_swap_b32 v24, v26
    v_add_u32 v54, s24, v55
    s_nop 0
    v_add_f32 v24, v24, v26
    s_nop 0
    ds_write_b32 v54, v24
    s_waitcnt lgkmcnt(0)
    s_barrier
    s_cmp_eq_u32 s20, 4
    s_cbranch_scc0 K0_pdone
    v_add_u32 v54, 132352, v55
    ds_read_b32 v36, v54
    ds_read_b32 v37, v54 offset:256
    ds_read_b32 v38, v54 offset:512
    ds_read_b32 v39, v54 offset:768
    s_cmp_eq_u32 s63, 1
    s_cbranch_scc1 K0_pdone0
    s_branch K0_pchk
K0_poll:
    s_sleep 1
    buffer_load_dwordx2 v[32:33], v30, s[52:55], s60 offen sc1
    s_waitcnt vmcnt(0)
K0_pchk:
    v_and_b32 v32, v32, v33
    s_nop 0
    v_readfirstlane_b32 s24, v32
    s_cmp_eq_u32 s24, 0x01010101
    s_cbranch_scc0 K0_poll
    buffer_load_dwordx4 v[28:31], v34, s[16:19], s62 offen sc1
K0_pdone0:
    s_waitcnt lgkmcnt(0)
    v_add_f32 v36, v36, v37
    v_add_f32 v38, v38, v39
    v_add_u32 v54, 132096, v55
    v_add_f32 v36, v36, v38
    v_add_u32 v55, 131072, v34
    ds_write_b32 v54, v36
    s_waitcnt vmcnt(0)
    ds_write_b128 v55, v[28:31]
K0_pdone:
    s_waitcnt lgkmcnt(0)
    s_barrier
    s_endpgm
K0_gemm:
    s_lshr_b32 s22, s20, 1
    s_and_b32 s50, s20, 1
    s_waitcnt lgkmcnt(0)
    s_mov_b32 s8, s36
    s_mov_b32 s9, s37
    s_mov_b32 s10, 0x200000
    s_mov_b32 s11, 0x20000
    s_mov_b32 s16, s42
    s_mov_b32 s17, s43
    s_mov_b32 s18, 0x1600000
    s_mov_b32 s19, 0x20000
    v_and_b32 v2, 31, v1
    v_lshrrev_b32 v3, 5, v1
    v_lshrrev_b32 v4, 1, v2
    v_and_b32 v4, 7, v4
    v_xor_b32 v4, v4, v3
    s_lshl_b32 s24, s22, 13
    v_lshlrev_b32 v2, 7, v2
    v_add_u32 v2, s24, v2
    v_xor_b32 v8, 0, v4
    v_lshl_add_u32 v8, v8, 4, v2
    v_xor_b32 v9, 2, v4
    v_lshl_add_u32 v9, v9, 4, v2
    v_xor_b32 v10, 4, v4
    v_lshl_add_u32 v10, v10, 4, v2
    v_xor_b32 v11, 6, v4
    v_lshl_add_u32 v11, v11, 4, v2
    v_lshrrev_b32 v3, 5, v1
    v_lshlrev_b32 v2, 10, v3
    v_bfe_u32 v3, v1, 2, 2
    v_lshl_add_u32 v2, v3, 7, v2
    v_bfe_u32 v4, v1, 4, 1
    v_lshl_add_u32 v2, v4, 5, v2
    v_and_b32 v4, 3, v1
    v_lshl_add_u32 v2, v4, 3, v2
    v_add_u32 v2, 65536, v2
    v_lshrrev_b32 v3, 1, v3
    v_xor_b32 v4, s50, v3
    v_lshl_add_u32 v12, v4, 6, v2
    v_mov_b32 v84, 0
    v_mov_b32 v85, 0
    v_mov_b32 v86, 0
    v_mov_b32 v87, 0
    v_mov_b32 v88, 0
    v_mov_b32 v89, 0
    v_mov_b32 v90, 0
    v_mov_b32 v91, 0
    v_mov_b32 v92, 0
    v_mov_b32 v93, 0
    v_mov_b32 v94, 0
    v_mov_b32 v95, 0
    v_mov_b32 v96, 0
    v_mov_b32 v97, 0
    v_mov_b32 v98, 0
    v_mov_b32 v99, 0
    v_mov_b32 v100, 0
    v_mov_b32 v101, 0
    v_mov_b32 v102, 0
    v_mov_b32 v103, 0
    v_mov_b32 v104, 0
    v_mov_b32 v105, 0
    v_mov_b32 v106, 0
    v_mov_b32 v107, 0
    v_mov_b32 v108, 0
    v_mov_b32 v109, 0
    v_mov_b32 v110, 0
    v_mov_b32 v111, 0
    v_mov_b32 v112, 0
    v_mov_b32 v113, 0
    v_mov_b32 v114, 0
    v_mov_b32 v115, 0
    v_mov_b32 v116, 0
    v_mov_b32 v117, 0
    v_mov_b32 v118, 0
    v_mov_b32 v119, 0
    v_mov_b32 v120, 0
    v_mov_b32 v121, 0
    v_mov_b32 v122, 0
    v_mov_b32 v123, 0
    v_mov_b32 v124, 0
    v_mov_b32 v125, 0
    v_mov_b32 v126, 0
    v_mov_b32 v127, 0
    v_mov_b32 v128, 0
    v_mov_b32 v129, 0
    v_mov_b32 v130, 0
    v_mov_b32 v131, 0
    v_mov_b32 v132, 0
    v_mov_b32 v133, 0
    v_mov_b32 v134, 0
    v_mov_b32 v135, 0
    v_mov_b32 v136, 0
    v_mov_b32 v137, 0
    v_mov_b32 v138, 0
    v_mov_b32 v139, 0
    v_mov_b32 v140, 0
    v_mov_b32 v141, 0
    v_mov_b32 v142, 0
    v_mov_b32 v143, 0
    v_mov_b32 v144, 0
    v_mov_b32 v145, 0
    v_mov_b32 v146, 0
    v_mov_b32 v147, 0
    v_mov_b32 v36, 0
    v_mov_b32 v68, 0
    v_mov_b32 v37, 0
    v_mov_b32 v69, 0
    v_mov_b32 v38, 0
    v_mov_b32 v70, 0
    v_mov_b32 v39, 0
    v_mov_b32 v71, 0
    v_mov_b32 v40, 0
    v_mov_b32 v72, 0
    v_mov_b32 v41, 0
    v_mov_b32 v73, 0
    v_mov_b32 v42, 0
    v_mov_b32 v74, 0
    v_mov_b32 v43, 0
    v_mov_b32 v75, 0
    v_mov_b32 v44, 0
    v_mov_b32 v76, 0
    v_mov_b32 v45, 0
    v_mov_b32 v77, 0
    v_mov_b32 v46, 0
    v_mov_b32 v78, 0
    v_mov_b32 v47, 0
    v_mov_b32 v79, 0
    v_mov_b32 v48, 0
    v_mov_b32 v80, 0
    v_mov_b32 v49, 0
    v_mov_b32 v81, 0
    v_mov_b32 v50, 0
    v_mov_b32 v82, 0
    v_mov_b32 v51, 0
    v_mov_b32 v83, 0
    s_mov_b32 s23, 0
    s_cmp_eq_u32 s49, 0
    s_cbranch_scc0 K0_gB
.p2align 6
K0_g0:
    s_waitcnt lgkmcnt(0)
    s_barrier
    v_mfma_f32_32x32x16_bf16 v[84:99], v[68:71], v[36:39], v[84:99]
    ds_read_b128 v[20:23], v8 offset:0
    ds_read_b128 v[24:27], v8 offset:4096
    v_mfma_f32_32x32x16_bf16 v[100:115], v[72:75], v[36:39], v[100:115]
    ds_read_b64_tr_b16 v[52:53], v12 offset:0
    ds_read_b64_tr_b16 v[54:55], v12 offset:512
    v_mfma_f32_32x32x16_bf16 v[116:131], v[68:71], v[40:43], v[116:131]
    ds_read_b64_tr_b16 v[56:57], v12 offset:8192
    ds_read_b64_tr_b16 v[58:59], v12 offset:8704
    v_mfma_f32_32x32x16_bf16 v[132:147], v[72:75], v[40:43], v[132:147]
    v_mfma_f32_32x32x16_bf16 v[84:99], v[76:79], v[44:47], v[84:99]
    ds_read_b128 v[28:31], v9 offset:0
    ds_read_b128 v[32:35], v9 offset:4096
    v_mfma_f32_32x32x16_bf16 v[100:115], v[80:83], v[44:47], v[100:115]
    ds_read_b64_tr_b16 v[60:61], v12 offset:2048
    ds_read_b64_tr_b16 v[62:63], v12 offset:2560
    v_mfma_f32_32x32x16_bf16 v[116:131], v[76:79], v[48:51], v[116:131]
    ds_read_b64_tr_b16 v[64:65], v12 offset:10240
    ds_read_b64_tr_b16 v[66:67], v12 offset:10752
    v_mfma_f32_32x32x16_bf16 v[132:147], v[80:83], v[48:51], v[132:147]
    s_waitcnt lgkmcnt(6)
    v_mfma_f32_32x32x16_bf16 v[84:99], v[52:55], v[20:23], v[84:99]
    ds_read_b128 v[36:39], v10 offset:0
    ds_read_b128 v[40:43], v10 offset:4096
    v_mfma_f32_32x32x16_bf16 v[100:115], v[56:59], v[20:23], v[100:115]
    ds_read_b64_tr_b16 v[68:69], v12 offset:4096
    ds_read_b64_tr_b16 v[70:71], v12 offset:4608
    v_mfma_f32_32x32x16_bf16 v[116:131], v[52:55], v[24:27], v[116:131]
    ds_read_b64_tr_b16 v[72:73], v12 offset:12288
    ds_read_b64_tr_b16 v[74:75], v12 offset:12800
    v_mfma_f32_32x32x16_bf16 v[132:147], v[56:59], v[24:27], v[132:147]
    s_waitcnt lgkmcnt(6)
    v_mfma_f32_32x32x16_bf16 v[84:99], v[60:63], v[28:31], v[84:99]
    ds_read_b128 v[44:47], v11 offset:0
    ds_read_b128 v[48:51], v11 offset:4096
    ds_read_b64_tr_b16 v[76:77], v12 offset:6144
    v_mfma_f32_32x32x16_bf16 v[100:115], v[64:67], v[28:31], v[100:115]
    ds_read_b64_tr_b16 v[78:79], v12 offset:6656
    ds_read_b64_tr_b16 v[80:81], v12 offset:14336
    ds_read_b64_tr_b16 v[82:83], v12 offset:14848
    v_mfma_f32_32x32x16_bf16 v[116:131], v[60:63], v[32:35], v[116:131]
    v_mfma_f32_32x32x16_bf16 v[132:147], v[64:67], v[32:35], v[132:147]
    s_waitcnt lgkmcnt(0)
    s_barrier
    v_mfma_f32_32x32x16_bf16 v[84:99], v[68:71], v[36:39], v[84:99]
    ds_read_b128 v[20:23], v8 offset:16384
    ds_read_b128 v[24:27], v8 offset:20480
    v_mfma_f32_32x32x16_bf16 v[100:115], v[72:75], v[36:39], v[100:115]
    ds_read_b64_tr_b16 v[52:53], v12 offset:16384
    ds_read_b64_tr_b16 v[54:55], v12 offset:16896
    v_mfma_f32_32x32x16_bf16 v[116:131], v[68:71], v[40:43], v[116:131]
    ds_read_b64_tr_b16 v[56:57], v12 offset:24576
    ds_read_b64_tr_b16 v[58:59], v12 offset:25088
    v_mfma_f32_32x32x16_bf16 v[132:147], v[72:75], v[40:43], v[132:147]
    v_mfma_f32_32x32x16_bf16 v[84:99], v[76:79], v[44:47], v[84:99]
    ds_read_b128 v[28:31], v9 offset:16384
    ds_read_b128 v[32:35], v9 offset:20480
    v_mfma_f32_32x32x16_bf16 v[100:115], v[80:83], v[44:47], v[100:115]
    ds_read_b64_tr_b16 v[60:61], v12 offset:18432
    ds_read_b64_tr_b16 v[62:63], v12 offset:18944
    v_mfma_f32_32x32x16_bf16 v[116:131], v[76:79], v[48:51], v[116:131]
    ds_read_b64_tr_b16 v[64:65], v12 offset:26624
    ds_read_b64_tr_b16 v[66:67], v12 offset:27136
    v_mfma_f32_32x32x16_bf16 v[132:147], v[80:83], v[48:51], v[132:147]
    s_waitcnt lgkmcnt(6)
    v_mfma_f32_32x32x16_bf16 v[84:99], v[52:55], v[20:23], v[84:99]
    ds_read_b128 v[36:39], v10 offset:16384
    ds_read_b128 v[40:43], v10 offset:20480
    v_mfma_f32_32x32x16_bf16 v[100:115], v[56:59], v[20:23], v[100:115]
    ds_read_b64_tr_b16 v[68:69], v12 offset:20480
    ds_read_b64_tr_b16 v[70:71], v12 offset:20992
    v_mfma_f32_32x32x16_bf16 v[116:131], v[52:55], v[24:27], v[116:131]
    ds_read_b64_tr_b16 v[72:73], v12 offset:28672
    ds_read_b64_tr_b16 v[74:75], v12 offset:29184
    v_mfma_f32_32x32x16_bf16 v[132:147], v[56:59], v[24:27], v[132:147]
    s_waitcnt lgkmcnt(6)
    v_mfma_f32_32x32x16_bf16 v[84:99], v[60:63], v[28:31], v[84:99]
    ds_read_b128 v[44:47], v11 offset:16384
    ds_read_b128 v[48:51], v11 offset:20480
    ds_read_b64_tr_b16 v[76:77], v12 offset:22528
    v_mfma_f32_32x32x16_bf16 v[100:115], v[64:67], v[28:31], v[100:115]
    ds_read_b64_tr_b16 v[78:79], v12 offset:23040
    ds_read_b64_tr_b16 v[80:81], v12 offset:30720
    ds_read_b64_tr_b16 v[82:83], v12 offset:31232
    v_mfma_f32_32x32x16_bf16 v[116:131], v[60:63], v[32:35], v[116:131]
    v_mfma_f32_32x32x16_bf16 v[132:147], v[64:67], v[32:35], v[132:147]
    s_waitcnt lgkmcnt(0)
    s_barrier
    v_mfma_f32_32x32x16_bf16 v[84:99], v[68:71], v[36:39], v[84:99]
    ds_read_b128 v[20:23], v8 offset:32768
    ds_read_b128 v[24:27], v8 offset:36864
    v_mfma_f32_32x32x16_bf16 v[100:115], v[72:75], v[36:39], v[100:115]
    ds_read_b64_tr_b16 v[52:53], v12 offset:32768
    ds_read_b64_tr_b16 v[54:55], v12 offset:33280
    v_mfma_f32_32x32x16_bf16 v[116:131], v[68:71], v[40:43], v[116:131]
    ds_read_b64_tr_b16 v[56:57], v12 offset:40960
    ds_read_b64_tr_b16 v[58:59], v12 offset:41472
    v_mfma_f32_32x32x16_bf16 v[132:147], v[72:75], v[40:43], v[132:147]
    v_mfma_f32_32x32x16_bf16 v[84:99], v[76:79], v[44:47], v[84:99]
    ds_read_b128 v[28:31], v9 offset:32768
    ds_read_b128 v[32:35], v9 offset:36864
    v_mfma_f32_32x32x16_bf16 v[100:115], v[80:83], v[44:47], v[100:115]
    ds_read_b64_tr_b16 v[60:61], v12 offset:34816
    ds_read_b64_tr_b16 v[62:63], v12 offset:35328
    v_mfma_f32_32x32x16_bf16 v[116:131], v[76:79], v[48:51], v[116:131]
    ds_read_b64_tr_b16 v[64:65], v12 offset:43008
    ds_read_b64_tr_b16 v[66:67], v12 offset:43520
    v_mfma_f32_32x32x16_bf16 v[132:147], v[80:83], v[48:51], v[132:147]
    s_waitcnt lgkmcnt(6)
    v_mfma_f32_32x32x16_bf16 v[84:99], v[52:55], v[20:23], v[84:99]
    ds_read_b128 v[36:39], v10 offset:32768
    ds_read_b128 v[40:43], v10 offset:36864
    v_mfma_f32_32x32x16_bf16 v[100:115], v[56:59], v[20:23], v[100:115]
    ds_read_b64_tr_b16 v[68:69], v12 offset:36864
    ds_read_b64_tr_b16 v[70:71], v12 offset:37376
    v_mfma_f32_32x32x16_bf16 v[116:131], v[52:55], v[24:27], v[116:131]
    ds_read_b64_tr_b16 v[72:73], v12 offset:45056
    ds_read_b64_tr_b16 v[74:75], v12 offset:45568
    v_mfma_f32_32x32x16_bf16 v[132:147], v[56:59], v[24:27], v[132:147]
    s_waitcnt lgkmcnt(6)
    v_mfma_f32_32x32x16_bf16 v[84:99], v[60:63], v[28:31], v[84:99]
    ds_read_b128 v[44:47], v11 offset:32768
    ds_read_b128 v[48:51], v11 offset:36864
    ds_read_b64_tr_b16 v[76:77], v12 offset:38912
    v_mfma_f32_32x32x16_bf16 v[100:115], v[64:67], v[28:31], v[100:115]
    ds_read_b64_tr_b16 v[78:79], v12 offset:39424
    ds_read_b64_tr_b16 v[80:81], v12 offset:47104
    ds_read_b64_tr_b16 v[82:83], v12 offset:47616
    v_mfma_f32_32x32x16_bf16 v[116:131], v[60:63], v[32:35], v[116:131]
    v_mfma_f32_32x32x16_bf16 v[132:147], v[64:67], v[32:35], v[132:147]
    s_waitcnt lgkmcnt(0)
    s_barrier
    v_mfma_f32_32x32x16_bf16 v[84:99], v[68:71], v[36:39], v[84:99]
    ds_read_b128 v[20:23], v8 offset:49152
    ds_read_b128 v[24:27], v8 offset:53248
    v_mfma_f32_32x32x16_bf16 v[100:115], v[72:75], v[36:39], v[100:115]
    ds_read_b64_tr_b16 v[52:53], v12 offset:49152
    ds_read_b64_tr_b16 v[54:55], v12 offset:49664
    v_mfma_f32_32x32x16_bf16 v[116:131], v[68:71], v[40:43], v[116:131]
    ds_read_b64_tr_b16 v[56:57], v12 offset:57344
    ds_read_b64_tr_b16 v[58:59], v12 offset:57856
    v_mfma_f32_32x32x16_bf16 v[132:147], v[72:75], v[40:43], v[132:147]
    v_mfma_f32_32x32x16_bf16 v[84:99], v[76:79], v[44:47], v[84:99]
    ds_read_b128 v[28:31], v9 offset:49152
    ds_read_b128 v[32:35], v9 offset:53248
    v_mfma_f32_32x32x16_bf16 v[100:115], v[80:83], v[44:47], v[100:115]
    ds_read_b64_tr_b16 v[60:61], v12 offset:51200
    ds_read_b64_tr_b16 v[62:63], v12 offset:51712
    v_mfma_f32_32x32x16_bf16 v[116:131], v[76:79], v[48:51], v[116:131]
    ds_read_b64_tr_b16 v[64:65], v12 offset:59392
    ds_read_b64_tr_b16 v[66:67], v12 offset:59904
    v_mfma_f32_32x32x16_bf16 v[132:147], v[80:83], v[48:51], v[132:147]
    s_waitcnt lgkmcnt(6)
    v_mfma_f32_32x32x16_bf16 v[84:99], v[52:55], v[20:23], v[84:99]
    ds_read_b128 v[36:39], v10 offset:49152
    ds_read_b128 v[40:43], v10 offset:53248
    v_mfma_f32_32x32x16_bf16 v[100:115], v[56:59], v[20:23], v[100:115]
    ds_read_b64_tr_b16 v[68:69], v12 offset:53248
    ds_read_b64_tr_b16 v[70:71], v12 offset:53760
    v_mfma_f32_32x32x16_bf16 v[116:131], v[52:55], v[24:27], v[116:131]
    ds_read_b64_tr_b16 v[72:73], v12 offset:61440
    ds_read_b64_tr_b16 v[74:75], v12 offset:61952
    v_mfma_f32_32x32x16_bf16 v[132:147], v[56:59], v[24:27], v[132:147]
    s_waitcnt lgkmcnt(6)
    v_mfma_f32_32x32x16_bf16 v[84:99], v[60:63], v[28:31], v[84:99]
    ds_read_b128 v[44:47], v11 offset:49152
    ds_read_b128 v[48:51], v11 offset:53248
    ds_read_b64_tr_b16 v[76:77], v12 offset:55296
    v_mfma_f32_32x32x16_bf16 v[100:115], v[64:67], v[28:31], v[100:115]
    ds_read_b64_tr_b16 v[78:79], v12 offset:55808
    ds_read_b64_tr_b16 v[80:81], v12 offset:63488
    ds_read_b64_tr_b16 v[82:83], v12 offset:64000
    s_add_u32 s23, s23, 1
    s_cmp_lt_u32 s23, 2
    v_mfma_f32_32x32x16_bf16 v[116:131], v[60:63], v[32:35], v[116:131]
    v_mfma_f32_32x32x16_bf16 v[132:147], v[64:67], v[32:35], v[132:147]
    s_cbranch_scc1 K0_g0
    s_waitcnt lgkmcnt(0)
    v_mfma_f32_32x32x16_bf16 v[84:99], v[68:71], v[36:39], v[84:99]
    v_mfma_f32_32x32x16_bf16 v[100:115], v[72:75], v[36:39], v[100:115]
    v_mfma_f32_32x32x16_bf16 v[116:131], v[68:71], v[40:43], v[116:131]
    v_mfma_f32_32x32x16_bf16 v[132:147], v[72:75], v[40:43], v[132:147]
    v_mfma_f32_32x32x16_bf16 v[84:99], v[76:79], v[44:47], v[84:99]
    v_mfma_f32_32x32x16_bf16 v[100:115], v[80:83], v[44:47], v[100:115]
    v_mfma_f32_32x32x16_bf16 v[116:131], v[76:79], v[48:51], v[116:131]
    v_mfma_f32_32x32x16_bf16 v[132:147], v[80:83], v[48:51], v[132:147]
    v_lshlrev_b32 v2, 4, v1
    v_and_b32 v5, 31, v1
    v_lshrrev_b32 v6, 5, v1
    s_lshl_b32 s36, s21, 2
    s_lshl_b32 s24, s22, 1
    s_add_u32 s36, s36, s24
    s_lshl_b32 s37, s44, 2
    s_lshl_b32 s24, s50, 1
    s_add_u32 s37, s37, s24
    s_lshl_b32 s38, s37, 16
    s_lshl_b32 s25, s36, 10
    s_add_u32 s38, s38, s25
    v_and_b32 v7, 19, v5
    v_bfe_u32 v8, v5, 2, 1
    v_lshl_or_b32 v7, v8, 3, v7
    v_bfe_u32 v8, v5, 3, 1
    v_lshl_or_b32 v7, v8, 2, v7
    v_lshl_add_u32 v7, v6, 5, v7
    v_lshlrev_b32 v3, 4, v7
    s_mov_b32 s25, 0x3eb8aa3b
    s_nop 7
    v_cvt_pk_bf16_f32 v20, v100, v101
    v_cvt_pk_bf16_f32 v21, v102, v103
    v_cvt_pk_bf16_f32 v22, v104, v105
    v_cvt_pk_bf16_f32 v23, v106, v107
    v_cvt_pk_bf16_f32 v24, v108, v109
    v_cvt_pk_bf16_f32 v25, v110, v111
    v_cvt_pk_bf16_f32 v26, v112, v113
    v_cvt_pk_bf16_f32 v27, v114, v115
    s_add_u32 s24, s38, 0x200000
    buffer_store_dwordx4 v[20:23], v3, s[16:19], s24 offen
    s_add_u32 s24, s38, 0x210000
    buffer_store_dwordx4 v[24:27], v3, s[16:19], s24 offen
    v_cvt_pk_bf16_f32 v28, v132, v133
    v_cvt_pk_bf16_f32 v29, v134, v135
    v_cvt_pk_bf16_f32 v30, v136, v137
    v_cvt_pk_bf16_f32 v31, v138, v139
    v_cvt_pk_bf16_f32 v32, v140, v141
    v_cvt_pk_bf16_f32 v33, v142, v143
    v_cvt_pk_bf16_f32 v34, v144, v145
    v_cvt_pk_bf16_f32 v35, v146, v147
    s_add_u32 s24, s38, 0x200400
    buffer_store_dwordx4 v[28:31], v3, s[16:19], s24 offen
    s_add_u32 s24, s38, 0x210400
    buffer_store_dwordx4 v[32:35], v3, s[16:19], s24 offen
    v_mul_f32 v84, s25, v84
    v_mul_f32 v85, s25, v85
    v_mul_f32 v86, s25, v86
    v_mul_f32 v87, s25, v87
    v_mul_f32 v88, s25, v88
    v_mul_f32 v89, s25, v89
    v_mul_f32 v90, s25, v90
    v_mul_f32 v91, s25, v91
    v_mul_f32 v92, s25, v92
    v_mul_f32 v93, s25, v93
    v_mul_f32 v94, s25, v94
    v_mul_f32 v95, s25, v95
    v_mul_f32 v96, s25, v96
    v_mul_f32 v97, s25, v97
    v_mul_f32 v98, s25, v98
    v_mul_f32 v99, s25, v99
    v_cvt_pk_bf16_f32 v36, v84, v85
    v_cvt_pk_bf16_f32 v37, v86, v87
    v_cvt_pk_bf16_f32 v38, v88, v89
    v_cvt_pk_bf16_f32 v39, v90, v91
    v_cvt_pk_bf16_f32 v40, v92, v93
    v_cvt_pk_bf16_f32 v41, v94, v95
    v_cvt_pk_bf16_f32 v42, v96, v97
    v_cvt_pk_bf16_f32 v43, v98, v99
    s_add_u32 s24, s38, 0
    buffer_store_dwordx4 v[36:39], v2, s[16:19], s24 offen
    s_add_u32 s24, s38, 65536
    buffer_store_dwordx4 v[40:43], v2, s[16:19], s24 offen
    v_mul_f32 v116, s25, v116
    v_mul_f32 v117, s25, v117
    v_mul_f32 v118, s25, v118
    v_mul_f32 v119, s25, v119
    v_mul_f32 v120, s25, v120
    v_mul_f32 v121, s25, v121
    v_mul_f32 v122, s25, v122
    v_mul_f32 v123, s25, v123
    v_mul_f32 v124, s25, v124
    v_mul_f32 v125, s25, v125
    v_mul_f32 v126, s25, v126
    v_mul_f32 v127, s25, v127
    v_mul_f32 v128, s25, v128
    v_mul_f32 v129, s25, v129
    v_mul_f32 v130, s25, v130
    v_mul_f32 v131, s25, v131
    v_cvt_pk_bf16_f32 v44, v116, v117
    v_cvt_pk_bf16_f32 v45, v118, v119
    v_cvt_pk_bf16_f32 v46, v120, v121
    v_cvt_pk_bf16_f32 v47, v122, v123
    v_cvt_pk_bf16_f32 v48, v124, v125
    v_cvt_pk_bf16_f32 v49, v126, v127
    v_cvt_pk_bf16_f32 v50, v128, v129
    v_cvt_pk_bf16_f32 v51, v130, v131
    s_add_u32 s24, s38, 1024
    buffer_store_dwordx4 v[44:47], v2, s[16:19], s24 offen
    s_add_u32 s24, s38, 66560
    buffer_store_dwordx4 v[48:51], v2, s[16:19], s24 offen
    s_endpgm
K0_gB:
.p2align 6
K0_g1:
    s_waitcnt lgkmcnt(0)
    s_barrier
    v_mfma_f32_32x32x16_bf16 v[84:99], v[36:39], v[68:71], v[84:99]
    ds_read_b128 v[20:23], v8 offset:0
    ds_read_b128 v[24:27], v8 offset:4096
    v_mfma_f32_32x32x16_bf16 v[100:115], v[72:75], v[36:39], v[100:115]
    ds_read_b64_tr_b16 v[52:53], v12 offset:0
    ds_read_b64_tr_b16 v[54:55], v12 offset:512
    v_mfma_f32_32x32x16_bf16 v[116:131], v[40:43], v[68:71], v[116:131]
    ds_read_b64_tr_b16 v[56:57], v12 offset:8192
    ds_read_b64_tr_b16 v[58:59], v12 offset:8704
    v_mfma_f32_32x32x16_bf16 v[132:147], v[72:75], v[40:43], v[132:147]
    v_mfma_f32_32x32x16_bf16 v[84:99], v[44:47], v[76:79], v[84:99]
    ds_read_b128 v[28:31], v9 offset:0
    ds_read_b128 v[32:35], v9 offset:4096
    v_mfma_f32_32x32x16_bf16 v[100:115], v[80:83], v[44:47], v[100:115]
    ds_read_b64_tr_b16 v[60:61], v12 offset:2048
    ds_read_b64_tr_b16 v[62:63], v12 offset:2560
    v_mfma_f32_32x32x16_bf16 v[116:131], v[48:51], v[76:79], v[116:131]
    ds_read_b64_tr_b16 v[64:65], v12 offset:10240
    ds_read_b64_tr_b16 v[66:67], v12 offset:10752
    v_mfma_f32_32x32x16_bf16 v[132:147], v[80:83], v[48:51], v[132:147]
    s_waitcnt lgkmcnt(6)
    v_mfma_f32_32x32x16_bf16 v[84:99], v[20:23], v[52:55], v[84:99]
    ds_read_b128 v[36:39], v10 offset:0
    ds_read_b128 v[40:43], v10 offset:4096
    v_mfma_f32_32x32x16_bf16 v[100:115], v[56:59], v[20:23], v[100:115]
    ds_read_b64_tr_b16 v[68:69], v12 offset:4096
    ds_read_b64_tr_b16 v[70:71], v12 offset:4608
    v_mfma_f32_32x32x16_bf16 v[116:131], v[24:27], v[52:55], v[116:131]
    ds_read_b64_tr_b16 v[72:73], v12 offset:12288
    ds_read_b64_tr_b16 v[74:75], v12 offset:12800
    v_mfma_f32_32x32x16_bf16 v[132:147], v[56:59], v[24:27], v[132:147]
    s_waitcnt lgkmcnt(6)
    v_mfma_f32_32x32x16_bf16 v[84:99], v[28:31], v[60:63], v[84:99]
    ds_read_b128 v[44:47], v11 offset:0
    ds_read_b128 v[48:51], v11 offset:4096
    ds_read_b64_tr_b16 v[76:77], v12 offset:6144
    v_mfma_f32_32x32x16_bf16 v[100:115], v[64:67], v[28:31], v[100:115]
    ds_read_b64_tr_b16 v[78:79], v12 offset:6656
    ds_read_b64_tr_b16 v[80:81], v12 offset:14336
    ds_read_b64_tr_b16 v[82:83], v12 offset:14848
    v_mfma_f32_32x32x16_bf16 v[116:131], v[32:35], v[60:63], v[116:131]
    v_mfma_f32_32x32x16_bf16 v[132:147], v[64:67], v[32:35], v[132:147]
    s_waitcnt lgkmcnt(0)
    s_barrier
    v_mfma_f32_32x32x16_bf16 v[84:99], v[36:39], v[68:71], v[84:99]
    ds_read_b128 v[20:23], v8 offset:16384
    ds_read_b128 v[24:27], v8 offset:20480
    v_mfma_f32_32x32x16_bf16 v[100:115], v[72:75], v[36:39], v[100:115]
    ds_read_b64_tr_b16 v[52:53], v12 offset:16384
    ds_read_b64_tr_b16 v[54:55], v12 offset:16896
    v_mfma_f32_32x32x16_bf16 v[116:131], v[40:43], v[68:71], v[116:131]
    ds_read_b64_tr_b16 v[56:57], v12 offset:24576
    ds_read_b64_tr_b16 v[58:59], v12 offset:25088
    v_mfma_f32_32x32x16_bf16 v[132:147], v[72:75], v[40:43], v[132:147]
    v_mfma_f32_32x32x16_bf16 v[84:99], v[44:47], v[76:79], v[84:99]
    ds_read_b128 v[28:31], v9 offset:16384
    ds_read_b128 v[32:35], v9 offset:20480
    v_mfma_f32_32x32x16_bf16 v[100:115], v[80:83], v[44:47], v[100:115]
    ds_read_b64_tr_b16 v[60:61], v12 offset:18432
    ds_read_b64_tr_b16 v[62:63], v12 offset:18944
    v_mfma_f32_32x32x16_bf16 v[116:131], v[48:51], v[76:79], v[116:131]
    ds_read_b64_tr_b16 v[64:65], v12 offset:26624
    ds_read_b64_tr_b16 v[66:67], v12 offset:27136
    v_mfma_f32_32x32x16_bf16 v[132:147], v[80:83], v[48:51], v[132:147]
    s_waitcnt lgkmcnt(6)
    v_mfma_f32_32x32x16_bf16 v[84:99], v[20:23], v[52:55], v[84:99]
    ds_read_b128 v[36:39], v10 offset:16384
    ds_read_b128 v[40:43], v10 offset:20480
    v_mfma_f32_32x32x16_bf16 v[100:115], v[56:59], v[20:23], v[100:115]
    ds_read_b64_tr_b16 v[68:69], v12 offset:20480
    ds_read_b64_tr_b16 v[70:71], v12 offset:20992
    v_mfma_f32_32x32x16_bf16 v[116:131], v[24:27], v[52:55], v[116:131]
    ds_read_b64_tr_b16 v[72:73], v12 offset:28672
    ds_read_b64_tr_b16 v[74:75], v12 offset:29184
    v_mfma_f32_32x32x16_bf16 v[132:147], v[56:59], v[24:27], v[132:147]
    s_waitcnt lgkmcnt(6)
    v_mfma_f32_32x32x16_bf16 v[84:99], v[28:31], v[60:63], v[84:99]
    ds_read_b128 v[44:47], v11 offset:16384
    ds_read_b128 v[48:51], v11 offset:20480
    ds_read_b64_tr_b16 v[76:77], v12 offset:22528
    v_mfma_f32_32x32x16_bf16 v[100:115], v[64:67], v[28:31], v[100:115]
    ds_read_b64_tr_b16 v[78:79], v12 offset:23040
    ds_read_b64_tr_b16 v[80:81], v12 offset:30720
    ds_read_b64_tr_b16 v[82:83], v12 offset:31232
    v_mfma_f32_32x32x16_bf16 v[116:131], v[32:35], v[60:63], v[116:131]
    v_mfma_f32_32x32x16_bf16 v[132:147], v[64:67], v[32:35], v[132:147]
    s_waitcnt lgkmcnt(0)
    s_barrier
    v_mfma_f32_32x32x16_bf16 v[84:99], v[36:39], v[68:71], v[84:99]
    ds_read_b128 v[20:23], v8 offset:32768
    ds_read_b128 v[24:27], v8 offset:36864
    v_mfma_f32_32x32x16_bf16 v[100:115], v[72:75], v[36:39], v[100:115]
    ds_read_b64_tr_b16 v[52:53], v12 offset:32768
    ds_read_b64_tr_b16 v[54:55], v12 offset:33280
    v_mfma_f32_32x32x16_bf16 v[116:131], v[40:43], v[68:71], v[116:131]
    ds_read_b64_tr_b16 v[56:57], v12 offset:40960
    ds_read_b64_tr_b16 v[58:59], v12 offset:41472
    v_mfma_f32_32x32x16_bf16 v[132:147], v[72:75], v[40:43], v[132:147]
    v_mfma_f32_32x32x16_bf16 v[84:99], v[44:47], v[76:79], v[84:99]
    ds_read_b128 v[28:31], v9 offset:32768
    ds_read_b128 v[32:35], v9 offset:36864
    v_mfma_f32_32x32x16_bf16 v[100:115], v[80:83], v[44:47], v[100:115]
    ds_read_b64_tr_b16 v[60:61], v12 offset:34816
    ds_read_b64_tr_b16 v[62:63], v12 offset:35328
    v_mfma_f32_32x32x16_bf16 v[116:131], v[48:51], v[76:79], v[116:131]
    ds_read_b64_tr_b16 v[64:65], v12 offset:43008
    ds_read_b64_tr_b16 v[66:67], v12 offset:43520
    v_mfma_f32_32x32x16_bf16 v[132:147], v[80:83], v[48:51], v[132:147]
    s_waitcnt lgkmcnt(6)
    v_mfma_f32_32x32x16_bf16 v[84:99], v[20:23], v[52:55], v[84:99]
    ds_read_b128 v[36:39], v10 offset:32768
    ds_read_b128 v[40:43], v10 offset:36864
    v_mfma_f32_32x32x16_bf16 v[100:115], v[56:59], v[20:23], v[100:115]
    ds_read_b64_tr_b16 v[68:69], v12 offset:36864
    ds_read_b64_tr_b16 v[70:71], v12 offset:37376
    v_mfma_f32_32x32x16_bf16 v[116:131], v[24:27], v[52:55], v[116:131]
    ds_read_b64_tr_b16 v[72:73], v12 offset:45056
    ds_read_b64_tr_b16 v[74:75], v12 offset:45568
    v_mfma_f32_32x32x16_bf16 v[132:147], v[56:59], v[24:27], v[132:147]
    s_waitcnt lgkmcnt(6)
    v_mfma_f32_32x32x16_bf16 v[84:99], v[28:31], v[60:63], v[84:99]
    ds_read_b128 v[44:47], v11 offset:32768
    ds_read_b128 v[48:51], v11 offset:36864
    ds_read_b64_tr_b16 v[76:77], v12 offset:38912
    v_mfma_f32_32x32x16_bf16 v[100:115], v[64:67], v[28:31], v[100:115]
    ds_read_b64_tr_b16 v[78:79], v12 offset:39424
    ds_read_b64_tr_b16 v[80:81], v12 offset:47104
    ds_read_b64_tr_b16 v[82:83], v12 offset:47616
    v_mfma_f32_32x32x16_bf16 v[116:131], v[32:35], v[60:63], v[116:131]
    v_mfma_f32_32x32x16_bf16 v[132:147], v[64:67], v[32:35], v[132:147]
    s_waitcnt lgkmcnt(0)
    s_barrier
    v_mfma_f32_32x32x16_bf16 v[84:99], v[36:39], v[68:71], v[84:99]
    ds_read_b128 v[20:23], v8 offset:49152
    ds_read_b128 v[24:27], v8 offset:53248
    v_mfma_f32_32x32x16_bf16 v[100:115], v[72:75], v[36:39], v[100:115]
    ds_read_b64_tr_b16 v[52:53], v12 offset:49152
    ds_read_b64_tr_b16 v[54:55], v12 offset:49664
    v_mfma_f32_32x32x16_bf16 v[116:131], v[40:43], v[68:71], v[116:131]
    ds_read_b64_tr_b16 v[56:57], v12 offset:57344
    ds_read_b64_tr_b16 v[58:59], v12 offset:57856
    v_mfma_f32_32x32x16_bf16 v[132:147], v[72:75], v[40:43], v[132:147]
    v_mfma_f32_32x32x16_bf16 v[84:99], v[44:47], v[76:79], v[84:99]
    ds_read_b128 v[28:31], v9 offset:49152
    ds_read_b128 v[32:35], v9 offset:53248
    v_mfma_f32_32x32x16_bf16 v[100:115], v[80:83], v[44:47], v[100:115]
    ds_read_b64_tr_b16 v[60:61], v12 offset:51200
    ds_read_b64_tr_b16 v[62:63], v12 offset:51712
    v_mfma_f32_32x32x16_bf16 v[116:131], v[48:51], v[76:79], v[116:131]
    ds_read_b64_tr_b16 v[64:65], v12 offset:59392
    ds_read_b64_tr_b16 v[66:67], v12 offset:59904
    v_mfma_f32_32x32x16_bf16 v[132:147], v[80:83], v[48:51], v[132:147]
    s_waitcnt lgkmcnt(6)
    v_mfma_f32_32x32x16_bf16 v[84:99], v[20:23], v[52:55], v[84:99]
    ds_read_b128 v[36:39], v10 offset:49152
    ds_read_b128 v[40:43], v10 offset:53248
    v_mfma_f32_32x32x16_bf16 v[100:115], v[56:59], v[20:23], v[100:115]
    ds_read_b64_tr_b16 v[68:69], v12 offset:53248
    ds_read_b64_tr_b16 v[70:71], v12 offset:53760
    v_mfma_f32_32x32x16_bf16 v[116:131], v[24:27], v[52:55], v[116:131]
    ds_read_b64_tr_b16 v[72:73], v12 offset:61440
    ds_read_b64_tr_b16 v[74:75], v12 offset:61952
    v_mfma_f32_32x32x16_bf16 v[132:147], v[56:59], v[24:27], v[132:147]
    s_waitcnt lgkmcnt(6)
    v_mfma_f32_32x32x16_bf16 v[84:99], v[28:31], v[60:63], v[84:99]
    ds_read_b128 v[44:47], v11 offset:49152
    ds_read_b128 v[48:51], v11 offset:53248
    ds_read_b64_tr_b16 v[76:77], v12 offset:55296
    v_mfma_f32_32x32x16_bf16 v[100:115], v[64:67], v[28:31], v[100:115]
    ds_read_b64_tr_b16 v[78:79], v12 offset:55808
    ds_read_b64_tr_b16 v[80:81], v12 offset:63488
    ds_read_b64_tr_b16 v[82:83], v12 offset:64000
    s_add_u32 s23, s23, 1
    s_cmp_lt_u32 s23, 2
    v_mfma_f32_32x32x16_bf16 v[116:131], v[32:35], v[60:63], v[116:131]
    v_mfma_f32_32x32x16_bf16 v[132:147], v[64:67], v[32:35], v[132:147]
    s_cbranch_scc1 K0_g1
    s_waitcnt lgkmcnt(0)
    s_barrier
    v_mfma_f32_32x32x16_bf16 v[84:99], v[36:39], v[68:71], v[84:99]
    v_mfma_f32_32x32x16_bf16 v[100:115], v[72:75], v[36:39], v[100:115]
    v_mfma_f32_32x32x16_bf16 v[116:131], v[40:43], v[68:71], v[116:131]
    v_mfma_f32_32x32x16_bf16 v[132:147], v[72:75], v[40:43], v[132:147]
    v_mfma_f32_32x32x16_bf16 v[84:99], v[44:47], v[76:79], v[84:99]
    v_mfma_f32_32x32x16_bf16 v[100:115], v[80:83], v[44:47], v[100:115]
    v_mfma_f32_32x32x16_bf16 v[116:131], v[48:51], v[76:79], v[116:131]
    v_mfma_f32_32x32x16_bf16 v[132:147], v[80:83], v[48:51], v[132:147]
    v_lshlrev_b32 v2, 4, v1
    v_and_b32 v5, 31, v1
    v_lshrrev_b32 v6, 5, v1
    s_lshl_b32 s36, s21, 2
    s_lshl_b32 s24, s22, 1
    s_add_u32 s36, s36, s24
    s_lshl_b32 s37, s44, 2
    s_lshl_b32 s24, s50, 1
    s_add_u32 s37, s37, s24
    s_lshl_b32 s38, s37, 16
    s_lshl_b32 s25, s36, 10
    s_add_u32 s38, s38, s25
    v_lshrrev_b32 v7, 4, v5
    v_lshlrev_b32 v7, 16, v7
    v_lshl_add_u32 v7, v6, 8, v7
    v_and_b32 v8, 15, v5
    v_lshl_add_u32 v4, v8, 4, v7
    s_lshl_b32 s39, s36, 15
    s_lshl_b32 s25, s37, 10
    s_add_u32 s39, s39, s25
    s_add_u32 s39, s39, 0x608000
    s_lshl_b32 s25, s22, 9
    s_add_u32 s25, s25, 131072
    v_lshl_add_u32 v9, v5, 3, s25
    s_lshl_b32 s25, s50, 7
    s_add_u32 s25, s25, 132096
    v_lshl_add_u32 v10, v6, 4, s25
    s_nop 4
    v_cvt_pk_bf16_f32 v20, v84, v85
    v_cvt_pk_bf16_f32 v21, v86, v87
    v_cvt_pk_bf16_f32 v22, v88, v89
    v_cvt_pk_bf16_f32 v23, v90, v91
    v_cvt_pk_bf16_f32 v24, v92, v93
    v_cvt_pk_bf16_f32 v25, v94, v95
    v_cvt_pk_bf16_f32 v26, v96, v97
    v_cvt_pk_bf16_f32 v27, v98, v99
    s_add_u32 s24, s38, 0x400000
    buffer_store_dwordx4 v[20:23], v4, s[16:19], s24 offen
    buffer_store_dwordx4 v[24:27], v4, s[16:19], s24 offen offset:512
    v_cvt_pk_bf16_f32 v28, v116, v117
    v_cvt_pk_bf16_f32 v29, v118, v119
    v_cvt_pk_bf16_f32 v30, v120, v121
    v_cvt_pk_bf16_f32 v31, v122, v123
    v_cvt_pk_bf16_f32 v32, v124, v125
    v_cvt_pk_bf16_f32 v33, v126, v127
    v_cvt_pk_bf16_f32 v34, v128, v129
    v_cvt_pk_bf16_f32 v35, v130, v131
    s_add_u32 s24, s38, 0x400400
    buffer_store_dwordx4 v[28:31], v4, s[16:19], s24 offen
    buffer_store_dwordx4 v[32:35], v4, s[16:19], s24 offen offset:512
    s_barrier
    ds_read_b64 v[12:13], v9
    ds_read_b64 v[14:15], v9 offset:256
    ds_read_b128 v[36:39], v10 offset:0
    ds_read_b128 v[40:43], v10 offset:32
    ds_read_b128 v[44:47], v10 offset:64
    ds_read_b128 v[48:51], v10 offset:96
    v_mov_b32 v52, 0xc0135761
    v_mov_b32 v53, v52
    v_mov_b32 v54, 0xbdd2d3e8
    v_mov_b32 v55, v54
    v_mov_b32 v56, 1.0
    v_mov_b32 v57, 1.0
    s_waitcnt lgkmcnt(0)
    v_pk_mul_f32 v[100:101], v[100:101], v[12:13] op_sel_hi:[1,0]
    v_pk_mul_f32 v[102:103], v[102:103], v[12:13] op_sel_hi:[1,0]
    v_pk_mul_f32 v[104:105], v[104:105], v[12:13] op_sel_hi:[1,0]
    v_pk_mul_f32 v[106:107], v[106:107], v[12:13] op_sel_hi:[1,0]
    v_pk_mul_f32 v[108:109], v[108:109], v[12:13] op_sel_hi:[1,0]
    v_pk_mul_f32 v[110:111], v[110:111], v[12:13] op_sel_hi:[1,0]
    v_pk_mul_f32 v[112:113], v[112:113], v[12:13] op_sel_hi:[1,0]
    v_pk_mul_f32 v[114:115], v[114:115], v[12:13] op_sel_hi:[1,0]
    v_pk_fma_f32 v[100:101], v[36:37], v[12:13], v[100:101] op_sel:[0,1,0] op_sel_hi:[1,1,1]
    v_pk_fma_f32 v[102:103], v[38:39], v[12:13], v[102:103] op_sel:[0,1,0] op_sel_hi:[1,1,1]
    v_pk_fma_f32 v[104:105], v[40:41], v[12:13], v[104:105] op_sel:[0,1,0] op_sel_hi:[1,1,1]
    v_pk_fma_f32 v[106:107], v[42:43], v[12:13], v[106:107] op_sel:[0,1,0] op_sel_hi:[1,1,1]
    v_pk_fma_f32 v[108:109], v[44:45], v[12:13], v[108:109] op_sel:[0,1,0] op_sel_hi:[1,1,1]
    v_pk_fma_f32 v[110:111], v[46:47], v[12:13], v[110:111] op_sel:[0,1,0] op_sel_hi:[1,1,1]
    v_pk_fma_f32 v[112:113], v[48:49], v[12:13], v[112:113] op_sel:[0,1,0] op_sel_hi:[1,1,1]
    v_pk_fma_f32 v[114:115], v[50:51], v[12:13], v[114:115] op_sel:[0,1,0] op_sel_hi:[1,1,1]
    v_pk_mul_f32 v[60:61], v[100:101], v[100:101]
    v_pk_mul_f32 v[62:63], v[102:103], v[102:103]
    v_pk_mul_f32 v[64:65], v[104:105], v[104:105]
    v_pk_mul_f32 v[66:67], v[106:107], v[106:107]
    v_pk_fma_f32 v[60:61], v[60:61], v[54:55], v[52:53]
    v_pk_fma_f32 v[62:63], v[62:63], v[54:55], v[52:53]
    v_pk_fma_f32 v[64:65], v[64:65], v[54:55], v[52:53]
    v_pk_fma_f32 v[66:67], v[66:67], v[54:55], v[52:53]
    v_pk_mul_f32 v[60:61], v[60:61], v[100:101]
    v_pk_mul_f32 v[62:63], v[62:63], v[102:103]
    v_pk_mul_f32 v[64:65], v[64:65], v[104:105]
    v_pk_mul_f32 v[66:67], v[66:67], v[106:107]
    v_exp_f32 v60, v60
    v_exp_f32 v62, v62
    v_exp_f32 v64, v64
    v_exp_f32 v66, v66
    v_exp_f32 v61, v61
    v_exp_f32 v63, v63
    v_exp_f32 v65, v65
    v_exp_f32 v67, v67
    v_pk_add_f32 v[60:61], v[60:61], v[56:57]
    v_pk_add_f32 v[62:63], v[62:63], v[56:57]
    v_pk_add_f32 v[64:65], v[64:65], v[56:57]
    v_pk_add_f32 v[66:67], v[66:67], v[56:57]
    v_rcp_f32 v60, v60
    v_rcp_f32 v62, v62
    v_rcp_f32 v64, v64
    v_rcp_f32 v66, v66
    v_rcp_f32 v61, v61
    v_rcp_f32 v63, v63
    v_rcp_f32 v65, v65
    v_rcp_f32 v67, v67
    v_pk_mul_f32 v[100:101], v[100:101], v[60:61]
    v_pk_mul_f32 v[102:103], v[102:103], v[62:63]
    v_pk_mul_f32 v[104:105], v[104:105], v[64:65]
    v_pk_mul_f32 v[106:107], v[106:107], v[66:67]
    v_pk_mul_f32 v[60:61], v[108:109], v[108:109]
    v_pk_mul_f32 v[62:63], v[110:111], v[110:111]
    v_pk_mul_f32 v[64:65], v[112:113], v[112:113]
    v_pk_mul_f32 v[66:67], v[114:115], v[114:115]
    v_pk_fma_f32 v[60:61], v[60:61], v[54:55], v[52:53]
    v_pk_fma_f32 v[62:63], v[62:63], v[54:55], v[52:53]
    v_pk_fma_f32 v[64:65], v[64:65], v[54:55], v[52:53]
    v_pk_fma_f32 v[66:67], v[66:67], v[54:55], v[52:53]
    v_pk_mul_f32 v[60:61], v[60:61], v[108:109]
    v_pk_mul_f32 v[62:63], v[62:63], v[110:111]
    v_pk_mul_f32 v[64:65], v[64:65], v[112:113]
    v_pk_mul_f32 v[66:67], v[66:67], v[114:115]
    v_exp_f32 v60, v60
    v_exp_f32 v62, v62
    v_exp_f32 v64, v64
    v_exp_f32 v66, v66
    v_exp_f32 v61, v61
    v_exp_f32 v63, v63
    v_exp_f32 v65, v65
    v_exp_f32 v67, v67
    v_pk_add_f32 v[60:61], v[60:61], v[56:57]
    v_pk_add_f32 v[62:63], v[62:63], v[56:57]
    v_pk_add_f32 v[64:65], v[64:65], v[56:57]
    v_pk_add_f32 v[66:67], v[66:67], v[56:57]
    v_rcp_f32 v60, v60
    v_rcp_f32 v62, v62
    v_rcp_f32 v64, v64
    v_rcp_f32 v66, v66
    v_rcp_f32 v61, v61
    v_rcp_f32 v63, v63
    v_rcp_f32 v65, v65
    v_rcp_f32 v67, v67
    v_pk_mul_f32 v[108:109], v[108:109], v[60:61]
    v_pk_mul_f32 v[110:111], v[110:111], v[62:63]
    v_pk_mul_f32 v[112:113], v[112:113], v[64:65]
    v_pk_mul_f32 v[114:115], v[114:115], v[66:67]
    v_cvt_pk_bf16_f32 v72, v100, v101
    v_cvt_pk_bf16_f32 v73, v102, v103
    v_cvt_pk_bf16_f32 v74, v104, v105
    v_cvt_pk_bf16_f32 v75, v106, v107
    v_cvt_pk_bf16_f32 v76, v108, v109
    v_cvt_pk_bf16_f32 v77, v110, v111
    v_cvt_pk_bf16_f32 v78, v112, v113
    v_cvt_pk_bf16_f32 v79, v114, v115
    s_add_u32 s24, s39, 0
    buffer_store_dwordx4 v[72:75], v2, s[16:19], s24 offen
    buffer_store_dwordx4 v[76:79], v2, s[16:19], s24 offen offset:1024
    s_nop 1
    v_pk_mul_f32 v[132:133], v[132:133], v[14:15] op_sel_hi:[1,0]
    v_pk_mul_f32 v[134:135], v[134:135], v[14:15] op_sel_hi:[1,0]
    v_pk_mul_f32 v[136:137], v[136:137], v[14:15] op_sel_hi:[1,0]
    v_pk_mul_f32 v[138:139], v[138:139], v[14:15] op_sel_hi:[1,0]
    v_pk_mul_f32 v[140:141], v[140:141], v[14:15] op_sel_hi:[1,0]
    v_pk_mul_f32 v[142:143], v[142:143], v[14:15] op_sel_hi:[1,0]
    v_pk_mul_f32 v[144:145], v[144:145], v[14:15] op_sel_hi:[1,0]
    v_pk_mul_f32 v[146:147], v[146:147], v[14:15] op_sel_hi:[1,0]
    v_pk_fma_f32 v[132:133], v[36:37], v[14:15], v[132:133] op_sel:[0,1,0] op_sel_hi:[1,1,1]
    v_pk_fma_f32 v[134:135], v[38:39], v[14:15], v[134:135] op_sel:[0,1,0] op_sel_hi:[1,1,1]
    v_pk_fma_f32 v[136:137], v[40:41], v[14:15], v[136:137] op_sel:[0,1,0] op_sel_hi:[1,1,1]
    v_pk_fma_f32 v[138:139], v[42:43], v[14:15], v[138:139] op_sel:[0,1,0] op_sel_hi:[1,1,1]
    v_pk_fma_f32 v[140:141], v[44:45], v[14:15], v[140:141] op_sel:[0,1,0] op_sel_hi:[1,1,1]
    v_pk_fma_f32 v[142:143], v[46:47], v[14:15], v[142:143] op_sel:[0,1,0] op_sel_hi:[1,1,1]
    v_pk_fma_f32 v[144:145], v[48:49], v[14:15], v[144:145] op_sel:[0,1,0] op_sel_hi:[1,1,1]
    v_pk_fma_f32 v[146:147], v[50:51], v[14:15], v[146:147] op_sel:[0,1,0] op_sel_hi:[1,1,1]
    v_pk_mul_f32 v[60:61], v[132:133], v[132:133]
    v_pk_mul_f32 v[62:63], v[134:135], v[134:135]
    v_pk_mul_f32 v[64:65], v[136:137], v[136:137]
    v_pk_mul_f32 v[66:67], v[138:139], v[138:139]
    v_pk_fma_f32 v[60:61], v[60:61], v[54:55], v[52:53]
    v_pk_fma_f32 v[62:63], v[62:63], v[54:55], v[52:53]
    v_pk_fma_f32 v[64:65], v[64:65], v[54:55], v[52:53]
    v_pk_fma_f32 v[66:67], v[66:67], v[54:55], v[52:53]
    v_pk_mul_f32 v[60:61], v[60:61], v[132:133]
    v_pk_mul_f32 v[62:63], v[62:63], v[134:135]
    v_pk_mul_f32 v[64:65], v[64:65], v[136:137]
    v_pk_mul_f32 v[66:67], v[66:67], v[138:139]
    v_exp_f32 v60, v60
    v_exp_f32 v62, v62
    v_exp_f32 v64, v64
    v_exp_f32 v66, v66
    v_exp_f32 v61, v61
    v_exp_f32 v63, v63
    v_exp_f32 v65, v65
    v_exp_f32 v67, v67
    v_pk_add_f32 v[60:61], v[60:61], v[56:57]
    v_pk_add_f32 v[62:63], v[62:63], v[56:57]
    v_pk_add_f32 v[64:65], v[64:65], v[56:57]
    v_pk_add_f32 v[66:67], v[66:67], v[56:57]
    v_rcp_f32 v60, v60
    v_rcp_f32 v62, v62
    v_rcp_f32 v64, v64
    v_rcp_f32 v66, v66
    v_rcp_f32 v61, v61
    v_rcp_f32 v63, v63
    v_rcp_f32 v65, v65
    v_rcp_f32 v67, v67
    v_pk_mul_f32 v[132:133], v[132:133], v[60:61]
    v_pk_mul_f32 v[134:135], v[134:135], v[62:63]
    v_pk_mul_f32 v[136:137], v[136:137], v[64:65]
    v_pk_mul_f32 v[138:139], v[138:139], v[66:67]
    v_pk_mul_f32 v[60:61], v[140:141], v[140:141]
    v_pk_mul_f32 v[62:63], v[142:143], v[142:143]
    v_pk_mul_f32 v[64:65], v[144:145], v[144:145]
    v_pk_mul_f32 v[66:67], v[146:147], v[146:147]
    v_pk_fma_f32 v[60:61], v[60:61], v[54:55], v[52:53]
    v_pk_fma_f32 v[62:63], v[62:63], v[54:55], v[52:53]
    v_pk_fma_f32 v[64:65], v[64:65], v[54:55], v[52:53]
    v_pk_fma_f32 v[66:67], v[66:67], v[54:55], v[52:53]
    v_pk_mul_f32 v[60:61], v[60:61], v[140:141]
    v_pk_mul_f32 v[62:63], v[62:63], v[142:143]
    v_pk_mul_f32 v[64:65], v[64:65], v[144:145]
    v_pk_mul_f32 v[66:67], v[66:67], v[146:147]
    v_exp_f32 v60, v60
    v_exp_f32 v62, v62
    v_exp_f32 v64, v64
    v_exp_f32 v66, v66
    v_exp_f32 v61, v61
    v_exp_f32 v63, v63
    v_exp_f32 v65, v65
    v_exp_f32 v67, v67
    v_pk_add_f32 v[60:61], v[60:61], v[56:57]
    v_pk_add_f32 v[62:63], v[62:63], v[56:57]
    v_pk_add_f32 v[64:65], v[64:65], v[56:57]
    v_pk_add_f32 v[66:67], v[66:67], v[56:57]
    v_rcp_f32 v60, v60
    v_rcp_f32 v62, v62
    v_rcp_f32 v64, v64
    v_rcp_f32 v66, v66
    v_rcp_f32 v61, v61
    v_rcp_f32 v63, v63
    v_rcp_f32 v65, v65
    v_rcp_f32 v67, v67
    v_pk_mul_f32 v[140:141], v[140:141], v[60:61]
    v_pk_mul_f32 v[142:143], v[142:143], v[62:63]
    v_pk_mul_f32 v[144:145], v[144:145], v[64:65]
    v_pk_mul_f32 v[146:147], v[146:147], v[66:67]
    v_cvt_pk_bf16_f32 v72, v132, v133
    v_cvt_pk_bf16_f32 v73, v134, v135
    v_cvt_pk_bf16_f32 v74, v136, v137
    v_cvt_pk_bf16_f32 v75, v138, v139
    v_cvt_pk_bf16_f32 v76, v140, v141
    v_cvt_pk_bf16_f32 v77, v142, v143
    v_cvt_pk_bf16_f32 v78, v144, v145
    v_cvt_pk_bf16_f32 v79, v146, v147
    s_add_u32 s24, s39, 32768
    buffer_store_dwordx4 v[72:75], v2, s[16:19], s24 offen
    buffer_store_dwordx4 v[76:79], v2, s[16:19], s24 offen offset:1024
    s_nop 1
    s_endpgm
L_exit0:
    s_endpgm
.globl gated_mix__softmax_full_mha__mixer_s_mlp__prompt_kernel
.p2align 8
.type gated_mix__softmax_full_mha__mixer_s_mlp__prompt_kernel,@function
gated_mix__softmax_full_mha__mixer_s_mlp__prompt_kernel:
    s_cmp_ge_u32 s2, 512
    s_cbranch_scc1 L_exit1
    s_cmp_lt_u32 s2, 256
    s_cbranch_scc0 K1_att
    s_mov_b32 s3, s2
    s_load_dwordx2 s[40:41], s[0:1], 88
    s_load_dwordx2 s[42:43], s[0:1], 40
    s_load_dwordx2 s[44:45], s[0:1], 48
    s_load_dwordx2 s[46:47], s[0:1], 56
    s_load_dwordx2 s[52:53], s[0:1], 0
    v_lshrrev_b32 v8, 6, v0
    v_and_b32 v1, 63, v0
    v_readfirstlane_b32 s16, v8
    v_lshlrev_b32 v2, 4, v1
    s_cmp_ge_u32 s16, 4
    s_cbranch_scc1 K1C_exit
    s_lshr_b32 s17, s16, 1
    s_and_b32 s18, s16, 1
    s_lshl_b32 s30, s16, 11
    v_lshrrev_b32 v8, 3, v1
    v_bfe_u32 v9, v1, 4, 1
    v_lshlrev_b32 v9, 2, v9
    v_and_b32 v10, 7, v1
    v_xor_b32 v9, v9, v10
    v_lshlrev_b32 v9, 4, v9
    v_lshl_add_u32 v3, v8, 10, v9
    s_lshl_b32 s22, s17, 10
    v_add_u32 v4, s22, v2
    v_lshrrev_b32 v8, 5, v1
    v_lshlrev_b32 v8, 9, v8
    v_bfe_u32 v9, v1, 2, 2
    v_lshl_add_u32 v8, v9, 7, v8
    v_lshrrev_b32 v9, 1, v9
    v_xor_b32 v9, s18, v9
    v_lshl_add_u32 v8, v9, 6, v8
    v_bfe_u32 v9, v1, 4, 1
    v_lshl_add_u32 v8, v9, 5, v8
    v_and_b32 v9, 3, v1
    v_lshl_add_u32 v8, v9, 3, v8
    v_add_u32 v5, 8192, v8
    s_waitcnt lgkmcnt(0)
    s_mov_b32 s8, s40
    s_mov_b32 s9, s41
    s_mov_b32 s10, 0x1600000
    s_mov_b32 s11, 0x20000
    s_mov_b32 s48, s52
    s_mov_b32 s49, s53
    s_mov_b32 s50, 0x200000
    s_mov_b32 s51, 0x20000
    s_mov_b32 s15, 0x20000
    s_and_b32 s22, s3, 7
    s_lshr_b32 s23, s3, 3
    s_and_b32 s19, s23, 3
    s_lshl_b32 s22, s22, 2
    s_add_u32 s19, s19, s22
    s_lshr_b32 s20, s23, 2
    s_lshl_b32 s31, s19, 1
    s_add_u32 s31, s31, s17
    s_lshl_b32 s32, s20, 2
    s_lshl_b32 s22, s18, 1
    s_add_u32 s32, s32, s22
    v_and_b32 v8, 31, v1
    v_lshrrev_b32 v9, 5, v1
    v_lshlrev_b32 v9, 9, v9
    v_add_u32 v10, 31, v8
    v_and_b32 v60, 31, v10
    v_lshl_add_u32 v60, v60, 4, v9
    v_lshrrev_b32 v10, 5, v10
    v_lshl_add_u32 v60, v10, 15, v60
    v_add_u32 v10, 33, v8
    v_and_b32 v61, 31, v10
    v_lshl_add_u32 v61, v61, 4, v9
    v_lshrrev_b32 v10, 5, v10
    v_lshl_add_u32 v61, v10, 15, v61
    v_add_u32 v10, 30, v8
    v_and_b32 v62, 31, v10
    v_lshl_add_u32 v62, v62, 4, v9
    v_lshrrev_b32 v10, 5, v10
    v_lshl_add_u32 v62, v10, 15, v62
    v_add_u32 v10, 34, v8
    v_and_b32 v63, 31, v10
    v_lshl_add_u32 v63, v63, 4, v9
    v_lshrrev_b32 v10, 5, v10
    v_lshl_add_u32 v63, v10, 15, v63
    v_lshrrev_b32 v8, 3, v1
    v_and_b32 v9, 7, v1
    v_lshlrev_b32 v9, 4, v9
    v_lshl_add_u32 v10, v8, 10, v9
    s_lshl_b32 s22, s19, 6
    s_lshl_b32 s23, s16, 4
    s_add_u32 s22, s22, s23
    s_lshl_b32 s22, s22, 10
    s_lshl_b32 s23, s20, 7
    s_add_u32 s22, s22, s23
    s_lshl_b32 s23, s16, 11
    s_add_u32 m0, s23, 65536
    s_mov_b32 s12, s42
    s_mov_b32 s13, s43
    s_mov_b32 s14, 524288
    buffer_load_dwordx4 v10, s[48:51], s22 offen lds
    s_add_u32 m0, m0, 1024
    s_add_u32 s22, s22, 8192
    buffer_load_dwordx4 v10, s[48:51], s22 offen lds
    s_mov_b32 s26, s16
    s_lshl_b32 s22, s19, 1
    s_mul_i32 s27, s22, 32768
    s_add_u32 s27, s27, 0x600000
    s_lshl_b32 s28, s20, 7
    s_mov_b32 s29, 31
    s_mov_b32 s25, 0
    s_mov_b32 s24, 0
    s_min_u32 s22, s26, s29
    s_lshl_b32 s22, s22, 10
    s_add_u32 s22, s22, s27
    s_add_u32 m0, s25, s30
    s_nop 0
    buffer_load_dwordx4 v60, s[8:11], s22 offen  lds
    s_add_u32 m0, m0, 1024
    s_add_u32 s22, s22, 32768
    buffer_load_dwordx4 v60, s[8:11], s22 offen  lds
    s_add_u32 s22, s25, s30
    s_lshl_b32 s23, s26, 14
    s_add_u32 m0, s22, 8192
    s_add_u32 s23, s23, s28
    buffer_load_dwordx4 v3, s[12:15], s23 offen lds
    s_add_u32 m0, m0, 1024
    s_add_u32 s23, s23, 8192
    buffer_load_dwordx4 v3, s[12:15], s23 offen lds
    s_add_u32 s26, s26, 4
    s_add_u32 s25, s25, 16384
    s_cmp_eq_u32 s25, 65536
    s_cselect_b32 s25, 0, s25
    s_min_u32 s22, s26, s29
    s_lshl_b32 s22, s22, 10
    s_add_u32 s22, s22, s27
    s_add_u32 m0, s25, s30
    s_nop 0
    buffer_load_dwordx4 v60, s[8:11], s22 offen  lds
    s_add_u32 m0, m0, 1024
    s_add_u32 s22, s22, 32768
    buffer_load_dwordx4 v60, s[8:11], s22 offen  lds
    s_add_u32 s22, s25, s30
    s_lshl_b32 s23, s26, 14
    s_add_u32 m0, s22, 8192
    s_add_u32 s23, s23, s28
    buffer_load_dwordx4 v3, s[12:15], s23 offen lds
    s_add_u32 m0, m0, 1024
    s_add_u32 s23, s23, 8192
    buffer_load_dwordx4 v3, s[12:15], s23 offen lds
    s_add_u32 s26, s26, 4
    s_add_u32 s25, s25, 16384
    s_cmp_eq_u32 s25, 65536
    s_cselect_b32 s25, 0, s25
    s_min_u32 s22, s26, s29
    s_lshl_b32 s22, s22, 10
    s_add_u32 s22, s22, s27
    s_add_u32 m0, s25, s30
    s_nop 0
    buffer_load_dwordx4 v61, s[8:11], s22 offen  lds
    s_add_u32 m0, m0, 1024
    s_add_u32 s22, s22, 32768
    buffer_load_dwordx4 v61, s[8:11], s22 offen  lds
    s_add_u32 s22, s25, s30
    s_lshl_b32 s23, s26, 14
    s_add_u32 m0, s22, 8192
    s_add_u32 s23, s23, s28
    buffer_load_dwordx4 v3, s[12:15], s23 offen lds
    s_add_u32 m0, m0, 1024
    s_add_u32 s23, s23, 8192
    buffer_load_dwordx4 v3, s[12:15], s23 offen lds
    s_add_u32 s26, s26, 4
    s_add_u32 s25, s25, 16384
    s_cmp_eq_u32 s25, 65536
    s_cselect_b32 s25, 0, s25
    s_waitcnt vmcnt(8)
    s_barrier
    v_add_u32 v6, s24, v4
    v_add_u32 v7, s24, v5
    ds_read_b128 v[12:15], v6 offset:0
    ds_read_b64_tr_b16 v[28:29], v7 offset:0
    ds_read_b64_tr_b16 v[30:31], v7 offset:1024
    s_min_u32 s22, s26, s29
    s_lshl_b32 s22, s22, 10
    s_add_u32 s22, s22, s27
    s_add_u32 m0, s25, s30
    s_nop 0
    buffer_load_dwordx4 v61, s[8:11], s22 offen  lds
    s_add_u32 m0, m0, 1024
    s_add_u32 s22, s22, 32768
    buffer_load_dwordx4 v61, s[8:11], s22 offen  lds
    s_add_u32 s22, s25, s30
    s_lshl_b32 s23, s26, 14
    s_add_u32 m0, s22, 8192
    s_add_u32 s23, s23, s28
    buffer_load_dwordx4 v3, s[12:15], s23 offen lds
    s_add_u32 m0, m0, 1024
    s_add_u32 s23, s23, 8192
    buffer_load_dwordx4 v3, s[12:15], s23 offen lds
    s_add_u32 s26, s26, 4
    s_add_u32 s25, s25, 16384
    s_cmp_eq_u32 s25, 65536
    s_cselect_b32 s25, 0, s25
    s_add_u32 s24, s24, 16384
    s_cmp_eq_u32 s24, 65536
    s_cselect_b32 s24, 0, s24
    s_waitcnt lgkmcnt(0)
    v_mfma_f32_32x32x16_bf16 v[44:59], v[28:31], v[12:15], 0
    ds_read_b128 v[12:15], v6 offset:2048
    ds_read_b64_tr_b16 v[28:29], v7 offset:2048
    ds_read_b64_tr_b16 v[30:31], v7 offset:3072
    s_waitcnt lgkmcnt(0)
    v_mfma_f32_32x32x16_bf16 v[44:59], v[28:31], v[12:15], v[44:59]
    ds_read_b128 v[12:15], v6 offset:4096
    ds_read_b64_tr_b16 v[28:29], v7 offset:4096
    ds_read_b64_tr_b16 v[30:31], v7 offset:5120
    s_waitcnt lgkmcnt(0)
    v_mfma_f32_32x32x16_bf16 v[44:59], v[28:31], v[12:15], v[44:59]
    ds_read_b128 v[12:15], v6 offset:6144
    ds_read_b64_tr_b16 v[28:29], v7 offset:6144
    ds_read_b64_tr_b16 v[30:31], v7 offset:7168
    s_waitcnt lgkmcnt(0)
    v_mfma_f32_32x32x16_bf16 v[44:59], v[28:31], v[12:15], v[44:59]
    s_waitcnt vmcnt(8)
    s_barrier
    v_add_u32 v6, s24, v4
    v_add_u32 v7, s24, v5
    ds_read_b128 v[12:15], v6 offset:0
    ds_read_b64_tr_b16 v[28:29], v7 offset:0
    ds_read_b64_tr_b16 v[30:31], v7 offset:1024
    s_min_u32 s22, s26, s29
    s_lshl_b32 s22, s22, 10
    s_add_u32 s22, s22, s27
    s_add_u32 m0, s25, s30
    s_nop 0
    buffer_load_dwordx4 v62, s[8:11], s22 offen  lds
    s_add_u32 m0, m0, 1024
    s_add_u32 s22, s22, 32768
    buffer_load_dwordx4 v62, s[8:11], s22 offen  lds
    s_add_u32 s22, s25, s30
    s_lshl_b32 s23, s26, 14
    s_add_u32 m0, s22, 8192
    s_add_u32 s23, s23, s28
    buffer_load_dwordx4 v3, s[12:15], s23 offen lds
    s_add_u32 m0, m0, 1024
    s_add_u32 s23, s23, 8192
    buffer_load_dwordx4 v3, s[12:15], s23 offen lds
    s_add_u32 s26, s26, 4
    s_add_u32 s25, s25, 16384
    s_cmp_eq_u32 s25, 65536
    s_cselect_b32 s25, 0, s25
    s_add_u32 s24, s24, 16384
    s_cmp_eq_u32 s24, 65536
    s_cselect_b32 s24, 0, s24
    s_waitcnt lgkmcnt(0)
    v_mfma_f32_32x32x16_bf16 v[44:59], v[28:31], v[12:15], v[44:59]
    ds_read_b128 v[12:15], v6 offset:2048
    ds_read_b64_tr_b16 v[28:29], v7 offset:2048
    ds_read_b64_tr_b16 v[30:31], v7 offset:3072
    s_waitcnt lgkmcnt(0)
    v_mfma_f32_32x32x16_bf16 v[44:59], v[28:31], v[12:15], v[44:59]
    ds_read_b128 v[12:15], v6 offset:4096
    ds_read_b64_tr_b16 v[28:29], v7 offset:4096
    ds_read_b64_tr_b16 v[30:31], v7 offset:5120
    s_waitcnt lgkmcnt(0)
    v_mfma_f32_32x32x16_bf16 v[44:59], v[28:31], v[12:15], v[44:59]
    ds_read_b128 v[12:15], v6 offset:6144
    ds_read_b64_tr_b16 v[28:29], v7 offset:6144
    ds_read_b64_tr_b16 v[30:31], v7 offset:7168
    s_waitcnt lgkmcnt(0)
    v_mfma_f32_32x32x16_bf16 v[44:59], v[28:31], v[12:15], v[44:59]
    s_waitcnt vmcnt(8)
    s_barrier
    v_add_u32 v6, s24, v4
    v_add_u32 v7, s24, v5
    ds_read_b128 v[12:15], v6 offset:0
    ds_read_b64_tr_b16 v[28:29], v7 offset:0
    ds_read_b64_tr_b16 v[30:31], v7 offset:1024
    s_min_u32 s22, s26, s29
    s_lshl_b32 s22, s22, 10
    s_add_u32 s22, s22, s27
    s_add_u32 m0, s25, s30
    s_nop 0
    buffer_load_dwordx4 v62, s[8:11], s22 offen  lds
    s_add_u32 m0, m0, 1024
    s_add_u32 s22, s22, 32768
    buffer_load_dwordx4 v62, s[8:11], s22 offen  lds
    s_add_u32 s22, s25, s30
    s_lshl_b32 s23, s26, 14
    s_add_u32 m0, s22, 8192
    s_add_u32 s23, s23, s28
    buffer_load_dwordx4 v3, s[12:15], s23 offen lds
    s_add_u32 m0, m0, 1024
    s_add_u32 s23, s23, 8192
    buffer_load_dwordx4 v3, s[12:15], s23 offen lds
    s_add_u32 s26, s26, 4
    s_add_u32 s25, s25, 16384
    s_cmp_eq_u32 s25, 65536
    s_cselect_b32 s25, 0, s25
    s_add_u32 s24, s24, 16384
    s_cmp_eq_u32 s24, 65536
    s_cselect_b32 s24, 0, s24
    s_waitcnt lgkmcnt(0)
    v_mfma_f32_32x32x16_bf16 v[44:59], v[28:31], v[12:15], v[44:59]
    ds_read_b128 v[12:15], v6 offset:2048
    ds_read_b64_tr_b16 v[28:29], v7 offset:2048
    ds_read_b64_tr_b16 v[30:31], v7 offset:3072
    s_waitcnt lgkmcnt(0)
    v_mfma_f32_32x32x16_bf16 v[44:59], v[28:31], v[12:15], v[44:59]
    ds_read_b128 v[12:15], v6 offset:4096
    ds_read_b64_tr_b16 v[28:29], v7 offset:4096
    ds_read_b64_tr_b16 v[30:31], v7 offset:5120
    s_waitcnt lgkmcnt(0)
    v_mfma_f32_32x32x16_bf16 v[44:59], v[28:31], v[12:15], v[44:59]
    ds_read_b128 v[12:15], v6 offset:6144
    ds_read_b64_tr_b16 v[28:29], v7 offset:6144
    ds_read_b64_tr_b16 v[30:31], v7 offset:7168
    s_waitcnt lgkmcnt(0)
    v_mfma_f32_32x32x16_bf16 v[44:59], v[28:31], v[12:15], v[44:59]
    s_waitcnt vmcnt(8)
    s_barrier
    v_add_u32 v6, s24, v4
    v_add_u32 v7, s24, v5
    ds_read_b128 v[12:15], v6 offset:0
    ds_read_b64_tr_b16 v[28:29], v7 offset:0
    ds_read_b64_tr_b16 v[30:31], v7 offset:1024
    s_min_u32 s22, s26, s29
    s_lshl_b32 s22, s22, 10
    s_add_u32 s22, s22, s27
    s_add_u32 m0, s25, s30
    s_nop 0
    buffer_load_dwordx4 v63, s[8:11], s22 offen  lds
    s_add_u32 m0, m0, 1024
    s_add_u32 s22, s22, 32768
    buffer_load_dwordx4 v63, s[8:11], s22 offen  lds
    s_add_u32 s22, s25, s30
    s_lshl_b32 s23, s26, 14
    s_add_u32 m0, s22, 8192
    s_add_u32 s23, s23, s28
    buffer_load_dwordx4 v3, s[12:15], s23 offen lds
    s_add_u32 m0, m0, 1024
    s_add_u32 s23, s23, 8192
    buffer_load_dwordx4 v3, s[12:15], s23 offen lds
    s_add_u32 s26, s26, 4
    s_add_u32 s25, s25, 16384
    s_cmp_eq_u32 s25, 65536
    s_cselect_b32 s25, 0, s25
    s_add_u32 s24, s24, 16384
    s_cmp_eq_u32 s24, 65536
    s_cselect_b32 s24, 0, s24
    s_waitcnt lgkmcnt(0)
    v_mfma_f32_32x32x16_bf16 v[44:59], v[28:31], v[12:15], v[44:59]
    ds_read_b128 v[12:15], v6 offset:2048
    ds_read_b64_tr_b16 v[28:29], v7 offset:2048
    ds_read_b64_tr_b16 v[30:31], v7 offset:3072
    s_waitcnt lgkmcnt(0)
    v_mfma_f32_32x32x16_bf16 v[44:59], v[28:31], v[12:15], v[44:59]
    ds_read_b128 v[12:15], v6 offset:4096
    ds_read_b64_tr_b16 v[28:29], v7 offset:4096
    ds_read_b64_tr_b16 v[30:31], v7 offset:5120
    s_waitcnt lgkmcnt(0)
    v_mfma_f32_32x32x16_bf16 v[44:59], v[28:31], v[12:15], v[44:59]
    ds_read_b128 v[12:15], v6 offset:6144
    ds_read_b64_tr_b16 v[28:29], v7 offset:6144
    ds_read_b64_tr_b16 v[30:31], v7 offset:7168
    s_waitcnt lgkmcnt(0)
    v_mfma_f32_32x32x16_bf16 v[44:59], v[28:31], v[12:15], v[44:59]
    s_waitcnt vmcnt(8)
    s_barrier
    v_add_u32 v6, s24, v4
    v_add_u32 v7, s24, v5
    ds_read_b128 v[12:15], v6 offset:0
    ds_read_b64_tr_b16 v[28:29], v7 offset:0
    ds_read_b64_tr_b16 v[30:31], v7 offset:1024
    s_min_u32 s22, s26, s29
    s_lshl_b32 s22, s22, 10
    s_add_u32 s22, s22, s27
    s_add_u32 m0, s25, s30
    s_nop 0
    buffer_load_dwordx4 v63, s[8:11], s22 offen  lds
    s_add_u32 m0, m0, 1024
    s_add_u32 s22, s22, 32768
    buffer_load_dwordx4 v63, s[8:11], s22 offen  lds
    s_add_u32 s22, s25, s30
    s_lshl_b32 s23, s26, 14
    s_add_u32 m0, s22, 8192
    s_add_u32 s23, s23, s28
    buffer_load_dwordx4 v3, s[12:15], s23 offen lds
    s_add_u32 m0, m0, 1024
    s_add_u32 s23, s23, 8192
    buffer_load_dwordx4 v3, s[12:15], s23 offen lds
    s_add_u32 s26, s26, 4
    s_add_u32 s25, s25, 16384
    s_cmp_eq_u32 s25, 65536
    s_cselect_b32 s25, 0, s25
    s_add_u32 s24, s24, 16384
    s_cmp_eq_u32 s24, 65536
    s_cselect_b32 s24, 0, s24
    s_waitcnt lgkmcnt(0)
    v_mfma_f32_32x32x16_bf16 v[44:59], v[28:31], v[12:15], v[44:59]
    ds_read_b128 v[12:15], v6 offset:2048
    ds_read_b64_tr_b16 v[28:29], v7 offset:2048
    ds_read_b64_tr_b16 v[30:31], v7 offset:3072
    s_waitcnt lgkmcnt(0)
    v_mfma_f32_32x32x16_bf16 v[44:59], v[28:31], v[12:15], v[44:59]
    ds_read_b128 v[12:15], v6 offset:4096
    ds_read_b64_tr_b16 v[28:29], v7 offset:4096
    ds_read_b64_tr_b16 v[30:31], v7 offset:5120
    s_waitcnt lgkmcnt(0)
    v_mfma_f32_32x32x16_bf16 v[44:59], v[28:31], v[12:15], v[44:59]
    ds_read_b128 v[12:15], v6 offset:6144
    ds_read_b64_tr_b16 v[28:29], v7 offset:6144
    ds_read_b64_tr_b16 v[30:31], v7 offset:7168
    s_waitcnt lgkmcnt(0)
    v_mfma_f32_32x32x16_bf16 v[44:59], v[28:31], v[12:15], v[44:59]
    s_waitcnt vmcnt(8)
    s_barrier
    v_add_u32 v6, s24, v4
    v_add_u32 v7, s24, v5
    ds_read_b128 v[12:15], v6 offset:0
    ds_read_b64_tr_b16 v[28:29], v7 offset:0
    ds_read_b64_tr_b16 v[30:31], v7 offset:1024
    s_add_u32 s24, s24, 16384
    s_cmp_eq_u32 s24, 65536
    s_cselect_b32 s24, 0, s24
    s_waitcnt lgkmcnt(0)
    v_mfma_f32_32x32x16_bf16 v[44:59], v[28:31], v[12:15], v[44:59]
    ds_read_b128 v[12:15], v6 offset:2048
    ds_read_b64_tr_b16 v[28:29], v7 offset:2048
    ds_read_b64_tr_b16 v[30:31], v7 offset:3072
    s_waitcnt lgkmcnt(0)
    v_mfma_f32_32x32x16_bf16 v[44:59], v[28:31], v[12:15], v[44:59]
    ds_read_b128 v[12:15], v6 offset:4096
    ds_read_b64_tr_b16 v[28:29], v7 offset:4096
    ds_read_b64_tr_b16 v[30:31], v7 offset:5120
    s_waitcnt lgkmcnt(0)
    v_mfma_f32_32x32x16_bf16 v[44:59], v[28:31], v[12:15], v[44:59]
    ds_read_b128 v[12:15], v6 offset:6144
    ds_read_b64_tr_b16 v[28:29], v7 offset:6144
    ds_read_b64_tr_b16 v[30:31], v7 offset:7168
    s_waitcnt lgkmcnt(0)
    v_mfma_f32_32x32x16_bf16 v[44:59], v[28:31], v[12:15], v[44:59]
    s_waitcnt vmcnt(4)
    s_barrier
    v_add_u32 v6, s24, v4
    v_add_u32 v7, s24, v5
    ds_read_b128 v[12:15], v6 offset:0
    ds_read_b64_tr_b16 v[28:29], v7 offset:0
    ds_read_b64_tr_b16 v[30:31], v7 offset:1024
    s_add_u32 s24, s24, 16384
    s_cmp_eq_u32 s24, 65536
    s_cselect_b32 s24, 0, s24
    s_waitcnt lgkmcnt(0)
    v_mfma_f32_32x32x16_bf16 v[44:59], v[28:31], v[12:15], v[44:59]
    ds_read_b128 v[12:15], v6 offset:2048
    ds_read_b64_tr_b16 v[28:29], v7 offset:2048
    ds_read_b64_tr_b16 v[30:31], v7 offset:3072
    s_waitcnt lgkmcnt(0)
    v_mfma_f32_32x32x16_bf16 v[44:59], v[28:31], v[12:15], v[44:59]
    ds_read_b128 v[12:15], v6 offset:4096
    ds_read_b64_tr_b16 v[28:29], v7 offset:4096
    ds_read_b64_tr_b16 v[30:31], v7 offset:5120
    s_waitcnt lgkmcnt(0)
    v_mfma_f32_32x32x16_bf16 v[44:59], v[28:31], v[12:15], v[44:59]
    ds_read_b128 v[12:15], v6 offset:6144
    ds_read_b64_tr_b16 v[28:29], v7 offset:6144
    ds_read_b64_tr_b16 v[30:31], v7 offset:7168
    s_waitcnt lgkmcnt(0)
    v_mfma_f32_32x32x16_bf16 v[44:59], v[28:31], v[12:15], v[44:59]
    s_waitcnt vmcnt(0)
    s_barrier
    v_add_u32 v6, s24, v4
    v_add_u32 v7, s24, v5
    ds_read_b128 v[12:15], v6 offset:0
    ds_read_b64_tr_b16 v[28:29], v7 offset:0
    ds_read_b64_tr_b16 v[30:31], v7 offset:1024
    s_add_u32 s24, s24, 16384
    s_cmp_eq_u32 s24, 65536
    s_cselect_b32 s24, 0, s24
    s_waitcnt lgkmcnt(0)
    v_mfma_f32_32x32x16_bf16 v[44:59], v[28:31], v[12:15], v[44:59]
    ds_read_b128 v[12:15], v6 offset:2048
    ds_read_b64_tr_b16 v[28:29], v7 offset:2048
    ds_read_b64_tr_b16 v[30:31], v7 offset:3072
    s_waitcnt lgkmcnt(0)
    v_mfma_f32_32x32x16_bf16 v[44:59], v[28:31], v[12:15], v[44:59]
    ds_read_b128 v[12:15], v6 offset:4096
    ds_read_b64_tr_b16 v[28:29], v7 offset:4096
    ds_read_b64_tr_b16 v[30:31], v7 offset:5120
    s_waitcnt lgkmcnt(0)
    v_mfma_f32_32x32x16_bf16 v[44:59], v[28:31], v[12:15], v[44:59]
    ds_read_b128 v[12:15], v6 offset:6144
    ds_read_b64_tr_b16 v[28:29], v7 offset:6144
    ds_read_b64_tr_b16 v[30:31], v7 offset:7168
    s_waitcnt lgkmcnt(0)
    v_mfma_f32_32x32x16_bf16 v[44:59], v[28:31], v[12:15], v[44:59]
    v_and_b32 v8, 31, v1
    s_lshl_b32 s22, s17, 12
    v_lshl_add_u32 v8, v8, 7, s22
    v_lshrrev_b32 v9, 5, v1
    v_lshl_add_u32 v8, v9, 3, v8
    s_lshl_b32 s22, s18, 6
    s_add_u32 s22, s22, 65536
    v_add_u32 v8, s22, v8
    ds_read_b64 v[12:13], v8 offset:0
    ds_read_b64 v[14:15], v8 offset:16
    ds_read_b64 v[16:17], v8 offset:32
    ds_read_b64 v[18:19], v8 offset:48
    s_nop 4
    s_waitcnt lgkmcnt(0)
    v_lshlrev_b32 v20, 16, v12
    v_and_b32 v21, 0xffff0000, v12
    v_lshlrev_b32 v22, 16, v13
    v_and_b32 v23, 0xffff0000, v13
    v_lshlrev_b32 v24, 16, v14
    v_and_b32 v25, 0xffff0000, v14
    v_lshlrev_b32 v26, 16, v15
    v_and_b32 v27, 0xffff0000, v15
    v_lshlrev_b32 v28, 16, v16
    v_and_b32 v29, 0xffff0000, v16
    v_lshlrev_b32 v30, 16, v17
    v_and_b32 v31, 0xffff0000, v17
    v_lshlrev_b32 v32, 16, v18
    v_and_b32 v33, 0xffff0000, v18
    v_lshlrev_b32 v34, 16, v19
    v_and_b32 v35, 0xffff0000, v19
    v_pk_add_f32 v[44:45], v[44:45], v[20:21]
    v_pk_add_f32 v[46:47], v[46:47], v[22:23]
    v_pk_add_f32 v[48:49], v[48:49], v[24:25]
    v_pk_add_f32 v[50:51], v[50:51], v[26:27]
    v_pk_add_f32 v[52:53], v[52:53], v[28:29]
    v_pk_add_f32 v[54:55], v[54:55], v[30:31]
    v_pk_add_f32 v[56:57], v[56:57], v[32:33]
    v_pk_add_f32 v[58:59], v[58:59], v[34:35]
    v_cvt_pk_bf16_f32 v12, v44, v45
    v_cvt_pk_bf16_f32 v13, v46, v47
    v_cvt_pk_bf16_f32 v14, v48, v49
    v_cvt_pk_bf16_f32 v15, v50, v51
    v_cvt_pk_bf16_f32 v16, v52, v53
    v_cvt_pk_bf16_f32 v17, v54, v55
    v_cvt_pk_bf16_f32 v18, v56, v57
    v_cvt_pk_bf16_f32 v19, v58, v59
    s_lshl_b32 s22, s31, 5
    s_add_u32 s22, s22, s32
    s_lshl_b32 s22, s22, 10
    s_add_u32 s22, s22, 0x820000
    buffer_store_dwordx4 v[12:15], v2, s[8:11], s22 offen sc1
    buffer_store_dwordx4 v[16:19], v2, s[8:11], s22 offen offset:1024 sc1
    v_lshlrev_b32 v20, 16, v12
    v_and_b32 v21, 0xffff0000, v12
    v_lshlrev_b32 v22, 16, v13
    v_and_b32 v23, 0xffff0000, v13
    v_lshlrev_b32 v24, 16, v14
    v_and_b32 v25, 0xffff0000, v14
    v_lshlrev_b32 v26, 16, v15
    v_and_b32 v27, 0xffff0000, v15
    v_lshlrev_b32 v28, 16, v16
    v_and_b32 v29, 0xffff0000, v16
    v_lshlrev_b32 v30, 16, v17
    v_and_b32 v31, 0xffff0000, v17
    v_lshlrev_b32 v32, 16, v18
    v_and_b32 v33, 0xffff0000, v18
    v_lshlrev_b32 v34, 16, v19
    v_and_b32 v35, 0xffff0000, v19
    v_pk_add_f32 v[40:41], v[20:21], v[22:23]
    v_pk_mul_f32 v[42:43], v[20:21], v[20:21]
    v_pk_fma_f32 v[42:43], v[22:23], v[22:23], v[42:43]
    v_pk_add_f32 v[40:41], v[40:41], v[24:25]
    v_pk_fma_f32 v[42:43], v[24:25], v[24:25], v[42:43]
    v_pk_add_f32 v[40:41], v[40:41], v[26:27]
    v_pk_fma_f32 v[42:43], v[26:27], v[26:27], v[42:43]
    v_pk_add_f32 v[40:41], v[40:41], v[28:29]
    v_pk_fma_f32 v[42:43], v[28:29], v[28:29], v[42:43]
    v_pk_add_f32 v[40:41], v[40:41], v[30:31]
    v_pk_fma_f32 v[42:43], v[30:31], v[30:31], v[42:43]
    v_pk_add_f32 v[40:41], v[40:41], v[32:33]
    v_pk_fma_f32 v[42:43], v[32:33], v[32:33], v[42:43]
    v_pk_add_f32 v[40:41], v[40:41], v[34:35]
    v_pk_fma_f32 v[42:43], v[34:35], v[34:35], v[42:43]
    v_add_f32 v40, v40, v41
    v_add_f32 v42, v42, v43
    v_and_b32 v8, 31, v1
    s_lshl_b32 s22, s16, 9
    v_lshrrev_b32 v9, 5, v1
    v_lshl_add_u32 v8, v8, 3, s22
    v_mov_b32 v41, v42
    v_lshl_add_u32 v8, v9, 8, v8
    s_barrier
    ds_write_b64 v8, v[40:41]
    s_waitcnt vmcnt(0) lgkmcnt(0)
    s_barrier
    s_lshr_b32 s22, s19, 1
    s_lshl_b32 s22, s22, 7
    s_and_b32 s23, s19, 1
    s_lshl_b32 s23, s23, 3
    s_add_u32 s23, s23, s20
    s_lshl_b32 s23, s23, 2
    s_add_u32 s33, s22, s23
    s_add_u32 s33, s33, 0x1480000
    s_cmp_eq_u32 s16, 0
    s_cbranch_scc0 K1C0_done
    v_lshrrev_b32 v8, 5, v1
    v_lshlrev_b32 v8, 10, v8
    v_and_b32 v9, 31, v1
    v_lshl_add_u32 v8, v9, 3, v8
    ds_read_b64 v[20:21], v8
    ds_read_b64 v[22:23], v8 offset:256
    ds_read_b64 v[24:25], v8 offset:512
    ds_read_b64 v[26:27], v8 offset:768
    s_lshl_b32 s22, s19, 6
    v_add_u32 v8, s22, v1
    v_lshlrev_b32 v9, 6, v8
    s_lshl_b32 s22, s20, 3
    s_add_u32 s22, s22, 0x1400000
    s_waitcnt lgkmcnt(0)
    v_pk_add_f32 v[20:21], v[20:21], v[22:23]
    v_pk_add_f32 v[24:25], v[24:25], v[26:27]
    v_pk_add_f32 v[20:21], v[20:21], v[24:25]
    buffer_store_dwordx2 v[20:21], v9, s[8:11], s22 offen sc1
    s_waitcnt vmcnt(0)
    v_mov_b32 v8, 1
    v_mov_b32 v9, 0
    s_mov_b64 exec, 1
    buffer_store_dword v8, v9, s[8:11], s33 offen sc1
    s_mov_b64 exec, -1
K1C0_done:
    s_barrier
    s_and_b32 s22, s3, 7
    s_lshr_b32 s23, s3, 3
    s_lshr_b32 s39, s22, 1
    s_lshl_b32 s39, s39, 2
    s_and_b32 s40, s23, 3
    s_add_u32 s39, s39, s40
    s_and_b32 s40, s22, 1
    s_lshl_b32 s40, s40, 3
    s_lshr_b32 s23, s23, 2
    s_add_u32 s40, s40, s23
    s_cmp_ge_u32 s40, 15
    s_cbranch_scc1 K1C2_end
    s_lshl_b32 s37, s39, 2
    s_add_u32 s37, s37, s16
    s_mov_b32 s12, s44
    s_mov_b32 s13, s45
    s_mov_b32 s14, 1409024
    s_mul_i32 s30, s16, 3072
    s_mul_i32 s28, s16, 44032
    s_mul_i32 s22, s40, 192
    s_add_u32 s28, s28, s22
    v_lshrrev_b32 v8, 2, v1
    v_mul_u32_u24 v8, 2752, v8
    v_and_b32 v9, 3, v1
    v_lshl_add_u32 v3, v9, 4, v8
    s_lshl_b32 s38, s37, 15
    s_add_u32 s38, s38, 0x820000
    s_add_u32 m0, s30, 0
    s_add_u32 s22, s28, 0
    buffer_load_dwordx4 v3, s[12:15], s22 offen lds
    s_add_u32 m0, m0, 1024
    s_add_u32 s22, s22, 64
    buffer_load_dwordx4 v3, s[12:15], s22 offen lds
    s_add_u32 m0, m0, 1024
    s_add_u32 s22, s22, 64
    buffer_load_dwordx4 v3, s[12:15], s22 offen lds
    s_add_u32 m0, s30, 12288
    s_add_u32 s22, s28, 176128
    buffer_load_dwordx4 v3, s[12:15], s22 offen lds
    s_add_u32 m0, m0, 1024
    s_add_u32 s22, s22, 64
    buffer_load_dwordx4 v3, s[12:15], s22 offen lds
    s_add_u32 m0, m0, 1024
    s_add_u32 s22, s22, 64
    buffer_load_dwordx4 v3, s[12:15], s22 offen lds
    s_add_u32 m0, s30, 24576
    s_add_u32 s22, s28, 352256
    buffer_load_dwordx4 v3, s[12:15], s22 offen lds
    s_add_u32 m0, m0, 1024
    s_add_u32 s22, s22, 64
    buffer_load_dwordx4 v3, s[12:15], s22 offen lds
    s_add_u32 m0, m0, 1024
    s_add_u32 s22, s22, 64
    buffer_load_dwordx4 v3, s[12:15], s22 offen lds
    s_add_u32 m0, s30, 36864
    s_add_u32 s22, s28, 528384
    buffer_load_dwordx4 v3, s[12:15], s22 offen lds
    s_add_u32 m0, m0, 1024
    s_add_u32 s22, s22, 64
    buffer_load_dwordx4 v3, s[12:15], s22 offen lds
    s_add_u32 m0, m0, 1024
    s_add_u32 s22, s22, 64
    buffer_load_dwordx4 v3, s[12:15], s22 offen lds
    s_add_u32 s34, s16, 0
    s_cmp_ge_u32 s34, 3
    s_cselect_b32 s22, 3, 0
    s_sub_u32 s34, s34, s22
    s_cmp_ge_u32 s34, 3
    s_cselect_b32 s22, 3, 0
    s_sub_u32 s34, s34, s22
    s_add_u32 s35, s16, 1
    s_cmp_ge_u32 s35, 3
    s_cselect_b32 s22, 3, 0
    s_sub_u32 s35, s35, s22
    s_cmp_ge_u32 s35, 3
    s_cselect_b32 s22, 3, 0
    s_sub_u32 s35, s35, s22
    s_add_u32 s36, s16, 2
    s_cmp_ge_u32 s36, 3
    s_cselect_b32 s22, 3, 0
    s_sub_u32 s36, s36, s22
    s_cmp_ge_u32 s36, 3
    s_cselect_b32 s22, 3, 0
    s_sub_u32 s36, s36, s22
    v_lshrrev_b32 v8, 5, v1
    v_lshlrev_b32 v8, 8, v8
    v_bfe_u32 v9, v1, 2, 2
    v_lshl_add_u32 v8, v9, 6, v8
    v_bfe_u32 v9, v1, 4, 1
    v_lshl_add_u32 v8, v9, 5, v8
    v_and_b32 v9, 3, v1
    v_lshl_add_u32 v8, v9, 3, v8
    s_lshl_b32 s22, s34, 10
    v_add_u32 v4, s22, v8
    s_lshl_b32 s22, s35, 10
    v_add_u32 v5, s22, v8
    s_lshl_b32 s22, s36, 10
    v_add_u32 v6, s22, v8
    v_mov_b32 v120, 0x3f803f80
    v_mov_b32 v121, 0x3f803f80
    v_mov_b32 v122, 0x3f803f80
    v_mov_b32 v123, 0x3f803f80
    s_lshl_b32 s23, s39, 7
    s_add_u32 s41, s23, 0x1480000
    s_cmp_eq_u32 s16, 0
    s_cbranch_scc0 K1C2f_wb
    v_min_u32 v8, 15, v1
    v_lshlrev_b32 v8, 2, v8
K1C2f_poll:
    buffer_load_dword v9, v8, s[8:11], s41 offen sc1
    s_waitcnt vmcnt(0)
    v_cmp_ne_u32 vcc, 1, v9
    s_nop 4
    s_cmp_eq_u64 vcc, 0
    s_cbranch_scc1 K1C2f_wb
    s_sleep 4
    s_branch K1C2f_poll
K1C2f_wb:
    s_barrier
    v_and_b32 v8, 31, v1
    v_lshlrev_b32 v8, 6, v8
    v_lshrrev_b32 v9, 5, v1
    v_lshl_add_u32 v8, v9, 5, v8
    s_lshl_b32 s22, s37, 11
    s_add_u32 s22, s22, 0x1400000
    buffer_load_dwordx4 v[92:95], v8, s[8:11], s22 offen sc1
    buffer_load_dwordx4 v[96:99], v8, s[8:11], s22 offen offset:16 sc1
    s_add_u32 s22, s38, 0
    buffer_load_dwordx4 v[12:15], v2, s[8:11], s22 offen sc1
    s_add_u32 s22, s38, 1024
    buffer_load_dwordx4 v[16:19], v2, s[8:11], s22 offen sc1
    s_add_u32 s22, s38, 2048
    buffer_load_dwordx4 v[20:23], v2, s[8:11], s22 offen sc1
    s_add_u32 s22, s38, 3072
    buffer_load_dwordx4 v[24:27], v2, s[8:11], s22 offen sc1
    s_add_u32 s22, s38, 4096
    buffer_load_dwordx4 v[28:31], v2, s[8:11], s22 offen sc1
    s_add_u32 s22, s38, 5120
    buffer_load_dwordx4 v[32:35], v2, s[8:11], s22 offen sc1
    s_add_u32 s22, s38, 6144
    buffer_load_dwordx4 v[36:39], v2, s[8:11], s22 offen sc1
    s_add_u32 s22, s38, 7168
    buffer_load_dwordx4 v[40:43], v2, s[8:11], s22 offen sc1
    s_waitcnt vmcnt(8)
    v_pk_add_f32 v[92:93], v[92:93], v[94:95]
    v_pk_add_f32 v[96:97], v[96:97], v[98:99]
    v_pk_add_f32 v[92:93], v[92:93], v[96:97]
    s_nop 0
    v_mov_b32 v94, v92
    v_mov_b32 v95, v93
    s_nop 1
    v_permlane32_swap_b32 v92, v94
    v_permlane32_swap_b32 v93, v95
    s_nop 1
    v_add_f32 v92, v92, v94
    v_add_f32 v93, v93, v95
    v_mul_f32 v92, 0x3b000000, v92
    v_mul_f32 v93, 0x3b000000, v93
    v_fma_f32 v93, -v92, v92, v93
    v_max_f32 v93, 0, v93
    v_add_f32 v93, 0x3727c5ac, v93
    v_rsq_f32 v124, v93
    s_nop 0
    v_mul_f32 v125, v92, v124
    v_sub_f32 v125, 0, v125
    s_waitcnt vmcnt(19)
    s_barrier
    ds_read_b64_tr_b16 v[108:109], v4 offset:0
    ds_read_b64_tr_b16 v[110:111], v4 offset:512
    ds_read_b64_tr_b16 v[112:113], v5 offset:0
    ds_read_b64_tr_b16 v[114:115], v5 offset:512
    s_add_u32 m0, s30, 49152
    s_add_u32 s22, s28, 704512
    buffer_load_dwordx4 v3, s[12:15], s22 offen lds
    s_add_u32 m0, m0, 1024
    s_add_u32 s22, s22, 64
    buffer_load_dwordx4 v3, s[12:15], s22 offen lds
    s_add_u32 m0, m0, 1024
    s_add_u32 s22, s22, 64
    buffer_load_dwordx4 v3, s[12:15], s22 offen lds
    s_waitcnt vmcnt(10) lgkmcnt(2)
    v_mfma_f32_32x32x16_bf16 v[44:59], v[108:111], v[12:15], 0
    v_mfma_f32_32x32x16_bf16 v[92:107], v[108:111], v[120:123], 0
    ds_read_b64_tr_b16 v[116:117], v6 offset:0
    ds_read_b64_tr_b16 v[118:119], v6 offset:512
    s_waitcnt lgkmcnt(2)
    v_mfma_f32_32x32x16_bf16 v[60:75], v[112:115], v[12:15], 0
    ds_read_b64_tr_b16 v[108:109], v4 offset:3072
    ds_read_b64_tr_b16 v[110:111], v4 offset:3584
    s_waitcnt lgkmcnt(2)
    v_mfma_f32_32x32x16_bf16 v[76:91], v[116:119], v[12:15], 0
    ds_read_b64_tr_b16 v[112:113], v5 offset:3072
    ds_read_b64_tr_b16 v[114:115], v5 offset:3584
    s_add_u32 s22, s38, 8192
    buffer_load_dwordx4 v[12:15], v2, s[8:11], s22 offen sc1
    s_waitcnt vmcnt(10) lgkmcnt(2)
    v_mfma_f32_32x32x16_bf16 v[44:59], v[108:111], v[16:19], v[44:59]
    v_mfma_f32_32x32x16_bf16 v[92:107], v[108:111], v[120:123], v[92:107]
    ds_read_b64_tr_b16 v[116:117], v6 offset:3072
    ds_read_b64_tr_b16 v[118:119], v6 offset:3584
    s_waitcnt lgkmcnt(2)
    v_mfma_f32_32x32x16_bf16 v[60:75], v[112:115], v[16:19], v[60:75]
    ds_read_b64_tr_b16 v[108:109], v4 offset:6144
    ds_read_b64_tr_b16 v[110:111], v4 offset:6656
    s_waitcnt lgkmcnt(2)
    v_mfma_f32_32x32x16_bf16 v[76:91], v[116:119], v[16:19], v[76:91]
    ds_read_b64_tr_b16 v[112:113], v5 offset:6144
    ds_read_b64_tr_b16 v[114:115], v5 offset:6656
    s_add_u32 s22, s38, 9216
    buffer_load_dwordx4 v[16:19], v2, s[8:11], s22 offen sc1
    s_waitcnt vmcnt(10) lgkmcnt(2)
    v_mfma_f32_32x32x16_bf16 v[44:59], v[108:111], v[20:23], v[44:59]
    v_mfma_f32_32x32x16_bf16 v[92:107], v[108:111], v[120:123], v[92:107]
    ds_read_b64_tr_b16 v[116:117], v6 offset:6144
    ds_read_b64_tr_b16 v[118:119], v6 offset:6656
    s_waitcnt lgkmcnt(2)
    v_mfma_f32_32x32x16_bf16 v[60:75], v[112:115], v[20:23], v[60:75]
    ds_read_b64_tr_b16 v[108:109], v4 offset:9216
    ds_read_b64_tr_b16 v[110:111], v4 offset:9728
    s_waitcnt lgkmcnt(2)
    v_mfma_f32_32x32x16_bf16 v[76:91], v[116:119], v[20:23], v[76:91]
    ds_read_b64_tr_b16 v[112:113], v5 offset:9216
    ds_read_b64_tr_b16 v[114:115], v5 offset:9728
    s_add_u32 s22, s38, 10240
    buffer_load_dwordx4 v[20:23], v2, s[8:11], s22 offen sc1
    s_waitcnt vmcnt(10) lgkmcnt(2)
    v_mfma_f32_32x32x16_bf16 v[44:59], v[108:111], v[24:27], v[44:59]
    v_mfma_f32_32x32x16_bf16 v[92:107], v[108:111], v[120:123], v[92:107]
    ds_read_b64_tr_b16 v[116:117], v6 offset:9216
    ds_read_b64_tr_b16 v[118:119], v6 offset:9728
    s_waitcnt lgkmcnt(2)
    v_mfma_f32_32x32x16_bf16 v[60:75], v[112:115], v[24:27], v[60:75]
    s_waitcnt lgkmcnt(0)
    v_mfma_f32_32x32x16_bf16 v[76:91], v[116:119], v[24:27], v[76:91]
    s_add_u32 s22, s38, 11264
    buffer_load_dwordx4 v[24:27], v2, s[8:11], s22 offen sc1
    s_waitcnt vmcnt(23)
    s_barrier
    ds_read_b64_tr_b16 v[108:109], v4 offset:12288
    ds_read_b64_tr_b16 v[110:111], v4 offset:12800
    ds_read_b64_tr_b16 v[112:113], v5 offset:12288
    ds_read_b64_tr_b16 v[114:115], v5 offset:12800
    s_add_u32 m0, s30, 0
    s_add_u32 s22, s28, 880640
    buffer_load_dwordx4 v3, s[12:15], s22 offen lds
    s_add_u32 m0, m0, 1024
    s_add_u32 s22, s22, 64
    buffer_load_dwordx4 v3, s[12:15], s22 offen lds
    s_add_u32 m0, m0, 1024
    s_add_u32 s22, s22, 64
    buffer_load_dwordx4 v3, s[12:15], s22 offen lds
    s_waitcnt vmcnt(13) lgkmcnt(2)
    v_mfma_f32_32x32x16_bf16 v[44:59], v[108:111], v[28:31], v[44:59]
    v_mfma_f32_32x32x16_bf16 v[92:107], v[108:111], v[120:123], v[92:107]
    ds_read_b64_tr_b16 v[116:117], v6 offset:12288
    ds_read_b64_tr_b16 v[118:119], v6 offset:12800
    s_waitcnt lgkmcnt(2)
    v_mfma_f32_32x32x16_bf16 v[60:75], v[112:115], v[28:31], v[60:75]
    ds_read_b64_tr_b16 v[108:109], v4 offset:15360
    ds_read_b64_tr_b16 v[110:111], v4 offset:15872
    s_waitcnt lgkmcnt(2)
    v_mfma_f32_32x32x16_bf16 v[76:91], v[116:119], v[28:31], v[76:91]
    ds_read_b64_tr_b16 v[112:113], v5 offset:15360
    ds_read_b64_tr_b16 v[114:115], v5 offset:15872
    s_add_u32 s22, s38, 12288
    buffer_load_dwordx4 v[28:31], v2, s[8:11], s22 offen sc1
    s_waitcnt vmcnt(13) lgkmcnt(2)
    v_mfma_f32_32x32x16_bf16 v[44:59], v[108:111], v[32:35], v[44:59]
    v_mfma_f32_32x32x16_bf16 v[92:107], v[108:111], v[120:123], v[92:107]
    ds_read_b64_tr_b16 v[116:117], v6 offset:15360
    ds_read_b64_tr_b16 v[118:119], v6 offset:15872
    s_waitcnt lgkmcnt(2)
    v_mfma_f32_32x32x16_bf16 v[60:75], v[112:115], v[32:35], v[60:75]
    ds_read_b64_tr_b16 v[108:109], v4 offset:18432
    ds_read_b64_tr_b16 v[110:111], v4 offset:18944
    s_waitcnt lgkmcnt(2)
    v_mfma_f32_32x32x16_bf16 v[76:91], v[116:119], v[32:35], v[76:91]
    ds_read_b64_tr_b16 v[112:113], v5 offset:18432
    ds_read_b64_tr_b16 v[114:115], v5 offset:18944
    s_add_u32 s22, s38, 13312
    buffer_load_dwordx4 v[32:35], v2, s[8:11], s22 offen sc1
    s_waitcnt vmcnt(13) lgkmcnt(2)
    v_mfma_f32_32x32x16_bf16 v[44:59], v[108:111], v[36:39], v[44:59]
    v_mfma_f32_32x32x16_bf16 v[92:107], v[108:111], v[120:123], v[92:107]
    ds_read_b64_tr_b16 v[116:117], v6 offset:18432
    ds_read_b64_tr_b16 v[118:119], v6 offset:18944
    s_waitcnt lgkmcnt(2)
    v_mfma_f32_32x32x16_bf16 v[60:75], v[112:115], v[36:39], v[60:75]
    ds_read_b64_tr_b16 v[108:109], v4 offset:21504
    ds_read_b64_tr_b16 v[110:111], v4 offset:22016
    s_waitcnt lgkmcnt(2)
    v_mfma_f32_32x32x16_bf16 v[76:91], v[116:119], v[36:39], v[76:91]
    ds_read_b64_tr_b16 v[112:113], v5 offset:21504
    ds_read_b64_tr_b16 v[114:115], v5 offset:22016
    s_add_u32 s22, s38, 14336
    buffer_load_dwordx4 v[36:39], v2, s[8:11], s22 offen sc1
    s_waitcnt vmcnt(13) lgkmcnt(2)
    v_mfma_f32_32x32x16_bf16 v[44:59], v[108:111], v[40:43], v[44:59]
    v_mfma_f32_32x32x16_bf16 v[92:107], v[108:111], v[120:123], v[92:107]
    ds_read_b64_tr_b16 v[116:117], v6 offset:21504
    ds_read_b64_tr_b16 v[118:119], v6 offset:22016
    s_waitcnt lgkmcnt(2)
    v_mfma_f32_32x32x16_bf16 v[60:75], v[112:115], v[40:43], v[60:75]
    s_waitcnt lgkmcnt(0)
    v_mfma_f32_32x32x16_bf16 v[76:91], v[116:119], v[40:43], v[76:91]
    s_add_u32 s22, s38, 15360
    buffer_load_dwordx4 v[40:43], v2, s[8:11], s22 offen sc1
    s_waitcnt vmcnt(27)
    s_barrier
    ds_read_b64_tr_b16 v[108:109], v4 offset:24576
    ds_read_b64_tr_b16 v[110:111], v4 offset:25088
    ds_read_b64_tr_b16 v[112:113], v5 offset:24576
    ds_read_b64_tr_b16 v[114:115], v5 offset:25088
    s_add_u32 m0, s30, 12288
    s_add_u32 s22, s28, 1056768
    buffer_load_dwordx4 v3, s[12:15], s22 offen lds
    s_add_u32 m0, m0, 1024
    s_add_u32 s22, s22, 64
    buffer_load_dwordx4 v3, s[12:15], s22 offen lds
    s_add_u32 m0, m0, 1024
    s_add_u32 s22, s22, 64
    buffer_load_dwordx4 v3, s[12:15], s22 offen lds
    s_waitcnt vmcnt(13) lgkmcnt(2)
    v_mfma_f32_32x32x16_bf16 v[44:59], v[108:111], v[12:15], v[44:59]
    v_mfma_f32_32x32x16_bf16 v[92:107], v[108:111], v[120:123], v[92:107]
    ds_read_b64_tr_b16 v[116:117], v6 offset:24576
    ds_read_b64_tr_b16 v[118:119], v6 offset:25088
    s_waitcnt lgkmcnt(2)
    v_mfma_f32_32x32x16_bf16 v[60:75], v[112:115], v[12:15], v[60:75]
    ds_read_b64_tr_b16 v[108:109], v4 offset:27648
    ds_read_b64_tr_b16 v[110:111], v4 offset:28160
    s_waitcnt lgkmcnt(2)
    v_mfma_f32_32x32x16_bf16 v[76:91], v[116:119], v[12:15], v[76:91]
    ds_read_b64_tr_b16 v[112:113], v5 offset:27648
    ds_read_b64_tr_b16 v[114:115], v5 offset:28160
    s_add_u32 s22, s38, 16384
    buffer_load_dwordx4 v[12:15], v2, s[8:11], s22 offen sc1
    s_waitcnt vmcnt(13) lgkmcnt(2)
    v_mfma_f32_32x32x16_bf16 v[44:59], v[108:111], v[16:19], v[44:59]
    v_mfma_f32_32x32x16_bf16 v[92:107], v[108:111], v[120:123], v[92:107]
    ds_read_b64_tr_b16 v[116:117], v6 offset:27648
    ds_read_b64_tr_b16 v[118:119], v6 offset:28160
    s_waitcnt lgkmcnt(2)
    v_mfma_f32_32x32x16_bf16 v[60:75], v[112:115], v[16:19], v[60:75]
    ds_read_b64_tr_b16 v[108:109], v4 offset:30720
    ds_read_b64_tr_b16 v[110:111], v4 offset:31232
    s_waitcnt lgkmcnt(2)
    v_mfma_f32_32x32x16_bf16 v[76:91], v[116:119], v[16:19], v[76:91]
    ds_read_b64_tr_b16 v[112:113], v5 offset:30720
    ds_read_b64_tr_b16 v[114:115], v5 offset:31232
    s_add_u32 s22, s38, 17408
    buffer_load_dwordx4 v[16:19], v2, s[8:11], s22 offen sc1
    s_waitcnt vmcnt(13) lgkmcnt(2)
    v_mfma_f32_32x32x16_bf16 v[44:59], v[108:111], v[20:23], v[44:59]
    v_mfma_f32_32x32x16_bf16 v[92:107], v[108:111], v[120:123], v[92:107]
    ds_read_b64_tr_b16 v[116:117], v6 offset:30720
    ds_read_b64_tr_b16 v[118:119], v6 offset:31232
    s_waitcnt lgkmcnt(2)
    v_mfma_f32_32x32x16_bf16 v[60:75], v[112:115], v[20:23], v[60:75]
    ds_read_b64_tr_b16 v[108:109], v4 offset:33792
    ds_read_b64_tr_b16 v[110:111], v4 offset:34304
    s_waitcnt lgkmcnt(2)
    v_mfma_f32_32x32x16_bf16 v[76:91], v[116:119], v[20:23], v[76:91]
    ds_read_b64_tr_b16 v[112:113], v5 offset:33792
    ds_read_b64_tr_b16 v[114:115], v5 offset:34304
    s_add_u32 s22, s38, 18432
    buffer_load_dwordx4 v[20:23], v2, s[8:11], s22 offen sc1
    s_waitcnt vmcnt(13) lgkmcnt(2)
    v_mfma_f32_32x32x16_bf16 v[44:59], v[108:111], v[24:27], v[44:59]
    v_mfma_f32_32x32x16_bf16 v[92:107], v[108:111], v[120:123], v[92:107]
    ds_read_b64_tr_b16 v[116:117], v6 offset:33792
    ds_read_b64_tr_b16 v[118:119], v6 offset:34304
    s_waitcnt lgkmcnt(2)
    v_mfma_f32_32x32x16_bf16 v[60:75], v[112:115], v[24:27], v[60:75]
    s_waitcnt lgkmcnt(0)
    v_mfma_f32_32x32x16_bf16 v[76:91], v[116:119], v[24:27], v[76:91]
    s_add_u32 s22, s38, 19456
    buffer_load_dwordx4 v[24:27], v2, s[8:11], s22 offen sc1
    s_waitcnt vmcnt(31)
    s_barrier
    ds_read_b64_tr_b16 v[108:109], v4 offset:36864
    ds_read_b64_tr_b16 v[110:111], v4 offset:37376
    ds_read_b64_tr_b16 v[112:113], v5 offset:36864
    ds_read_b64_tr_b16 v[114:115], v5 offset:37376
    s_add_u32 m0, s30, 24576
    s_add_u32 s22, s28, 1232896
    buffer_load_dwordx4 v3, s[12:15], s22 offen lds
    s_add_u32 m0, m0, 1024
    s_add_u32 s22, s22, 64
    buffer_load_dwordx4 v3, s[12:15], s22 offen lds
    s_add_u32 m0, m0, 1024
    s_add_u32 s22, s22, 64
    buffer_load_dwordx4 v3, s[12:15], s22 offen lds
    s_waitcnt vmcnt(13) lgkmcnt(2)
    v_mfma_f32_32x32x16_bf16 v[44:59], v[108:111], v[28:31], v[44:59]
    v_mfma_f32_32x32x16_bf16 v[92:107], v[108:111], v[120:123], v[92:107]
    ds_read_b64_tr_b16 v[116:117], v6 offset:36864
    ds_read_b64_tr_b16 v[118:119], v6 offset:37376
    s_waitcnt lgkmcnt(2)
    v_mfma_f32_32x32x16_bf16 v[60:75], v[112:115], v[28:31], v[60:75]
    ds_read_b64_tr_b16 v[108:109], v4 offset:39936
    ds_read_b64_tr_b16 v[110:111], v4 offset:40448
    s_waitcnt lgkmcnt(2)
    v_mfma_f32_32x32x16_bf16 v[76:91], v[116:119], v[28:31], v[76:91]
    ds_read_b64_tr_b16 v[112:113], v5 offset:39936
    ds_read_b64_tr_b16 v[114:115], v5 offset:40448
    s_add_u32 s22, s38, 20480
    buffer_load_dwordx4 v[28:31], v2, s[8:11], s22 offen sc1
    s_waitcnt vmcnt(13) lgkmcnt(2)
    v_mfma_f32_32x32x16_bf16 v[44:59], v[108:111], v[32:35], v[44:59]
    v_mfma_f32_32x32x16_bf16 v[92:107], v[108:111], v[120:123], v[92:107]
    ds_read_b64_tr_b16 v[116:117], v6 offset:39936
    ds_read_b64_tr_b16 v[118:119], v6 offset:40448
    s_waitcnt lgkmcnt(2)
    v_mfma_f32_32x32x16_bf16 v[60:75], v[112:115], v[32:35], v[60:75]
    ds_read_b64_tr_b16 v[108:109], v4 offset:43008
    ds_read_b64_tr_b16 v[110:111], v4 offset:43520
    s_waitcnt lgkmcnt(2)
    v_mfma_f32_32x32x16_bf16 v[76:91], v[116:119], v[32:35], v[76:91]
    ds_read_b64_tr_b16 v[112:113], v5 offset:43008
    ds_read_b64_tr_b16 v[114:115], v5 offset:43520
    s_add_u32 s22, s38, 21504
    buffer_load_dwordx4 v[32:35], v2, s[8:11], s22 offen sc1
    s_waitcnt vmcnt(13) lgkmcnt(2)
    v_mfma_f32_32x32x16_bf16 v[44:59], v[108:111], v[36:39], v[44:59]
    v_mfma_f32_32x32x16_bf16 v[92:107], v[108:111], v[120:123], v[92:107]
    ds_read_b64_tr_b16 v[116:117], v6 offset:43008
    ds_read_b64_tr_b16 v[118:119], v6 offset:43520
    s_waitcnt lgkmcnt(2)
    v_mfma_f32_32x32x16_bf16 v[60:75], v[112:115], v[36:39], v[60:75]
    ds_read_b64_tr_b16 v[108:109], v4 offset:46080
    ds_read_b64_tr_b16 v[110:111], v4 offset:46592
    s_waitcnt lgkmcnt(2)
    v_mfma_f32_32x32x16_bf16 v[76:91], v[116:119], v[36:39], v[76:91]
    ds_read_b64_tr_b16 v[112:113], v5 offset:46080
    ds_read_b64_tr_b16 v[114:115], v5 offset:46592
    s_add_u32 s22, s38, 22528
    buffer_load_dwordx4 v[36:39], v2, s[8:11], s22 offen sc1
    s_waitcnt vmcnt(13) lgkmcnt(2)
    v_mfma_f32_32x32x16_bf16 v[44:59], v[108:111], v[40:43], v[44:59]
    v_mfma_f32_32x32x16_bf16 v[92:107], v[108:111], v[120:123], v[92:107]
    ds_read_b64_tr_b16 v[116:117], v6 offset:46080
    ds_read_b64_tr_b16 v[118:119], v6 offset:46592
    s_waitcnt lgkmcnt(2)
    v_mfma_f32_32x32x16_bf16 v[60:75], v[112:115], v[40:43], v[60:75]
    s_waitcnt lgkmcnt(0)
    v_mfma_f32_32x32x16_bf16 v[76:91], v[116:119], v[40:43], v[76:91]
    s_add_u32 s22, s38, 23552
    buffer_load_dwordx4 v[40:43], v2, s[8:11], s22 offen sc1
    s_waitcnt vmcnt(25)
    s_barrier
    ds_read_b64_tr_b16 v[108:109], v4 offset:49152
    ds_read_b64_tr_b16 v[110:111], v4 offset:49664
    ds_read_b64_tr_b16 v[112:113], v5 offset:49152
    ds_read_b64_tr_b16 v[114:115], v5 offset:49664
    s_waitcnt vmcnt(10) lgkmcnt(2)
    v_mfma_f32_32x32x16_bf16 v[44:59], v[108:111], v[12:15], v[44:59]
    v_mfma_f32_32x32x16_bf16 v[92:107], v[108:111], v[120:123], v[92:107]
    ds_read_b64_tr_b16 v[116:117], v6 offset:49152
    ds_read_b64_tr_b16 v[118:119], v6 offset:49664
    s_waitcnt lgkmcnt(2)
    v_mfma_f32_32x32x16_bf16 v[60:75], v[112:115], v[12:15], v[60:75]
    ds_read_b64_tr_b16 v[108:109], v4 offset:52224
    ds_read_b64_tr_b16 v[110:111], v4 offset:52736
    s_waitcnt lgkmcnt(2)
    v_mfma_f32_32x32x16_bf16 v[76:91], v[116:119], v[12:15], v[76:91]
    ds_read_b64_tr_b16 v[112:113], v5 offset:52224
    ds_read_b64_tr_b16 v[114:115], v5 offset:52736
    s_add_u32 s22, s38, 24576
    buffer_load_dwordx4 v[12:15], v2, s[8:11], s22 offen sc1
    s_waitcnt vmcnt(10) lgkmcnt(2)
    v_mfma_f32_32x32x16_bf16 v[44:59], v[108:111], v[16:19], v[44:59]
    v_mfma_f32_32x32x16_bf16 v[92:107], v[108:111], v[120:123], v[92:107]
    ds_read_b64_tr_b16 v[116:117], v6 offset:52224
    ds_read_b64_tr_b16 v[118:119], v6 offset:52736
    s_waitcnt lgkmcnt(2)
    v_mfma_f32_32x32x16_bf16 v[60:75], v[112:115], v[16:19], v[60:75]
    ds_read_b64_tr_b16 v[108:109], v4 offset:55296
    ds_read_b64_tr_b16 v[110:111], v4 offset:55808
    s_waitcnt lgkmcnt(2)
    v_mfma_f32_32x32x16_bf16 v[76:91], v[116:119], v[16:19], v[76:91]
    ds_read_b64_tr_b16 v[112:113], v5 offset:55296
    ds_read_b64_tr_b16 v[114:115], v5 offset:55808
    s_add_u32 s22, s38, 25600
    buffer_load_dwordx4 v[16:19], v2, s[8:11], s22 offen sc1
    s_waitcnt vmcnt(10) lgkmcnt(2)
    v_mfma_f32_32x32x16_bf16 v[44:59], v[108:111], v[20:23], v[44:59]
    v_mfma_f32_32x32x16_bf16 v[92:107], v[108:111], v[120:123], v[92:107]
    ds_read_b64_tr_b16 v[116:117], v6 offset:55296
    ds_read_b64_tr_b16 v[118:119], v6 offset:55808
    s_waitcnt lgkmcnt(2)
    v_mfma_f32_32x32x16_bf16 v[60:75], v[112:115], v[20:23], v[60:75]
    ds_read_b64_tr_b16 v[108:109], v4 offset:58368
    ds_read_b64_tr_b16 v[110:111], v4 offset:58880
    s_waitcnt lgkmcnt(2)
    v_mfma_f32_32x32x16_bf16 v[76:91], v[116:119], v[20:23], v[76:91]
    ds_read_b64_tr_b16 v[112:113], v5 offset:58368
    ds_read_b64_tr_b16 v[114:115], v5 offset:58880
    s_add_u32 s22, s38, 26624
    buffer_load_dwordx4 v[20:23], v2, s[8:11], s22 offen sc1
    s_waitcnt vmcnt(10) lgkmcnt(2)
    v_mfma_f32_32x32x16_bf16 v[44:59], v[108:111], v[24:27], v[44:59]
    v_mfma_f32_32x32x16_bf16 v[92:107], v[108:111], v[120:123], v[92:107]
    ds_read_b64_tr_b16 v[116:117], v6 offset:58368
    ds_read_b64_tr_b16 v[118:119], v6 offset:58880
    s_waitcnt lgkmcnt(2)
    v_mfma_f32_32x32x16_bf16 v[60:75], v[112:115], v[24:27], v[60:75]
    s_waitcnt lgkmcnt(0)
    v_mfma_f32_32x32x16_bf16 v[76:91], v[116:119], v[24:27], v[76:91]
    s_add_u32 s22, s38, 27648
    buffer_load_dwordx4 v[24:27], v2, s[8:11], s22 offen sc1
    s_waitcnt vmcnt(22)
    s_barrier
    ds_read_b64_tr_b16 v[108:109], v4 offset:0
    ds_read_b64_tr_b16 v[110:111], v4 offset:512
    ds_read_b64_tr_b16 v[112:113], v5 offset:0
    ds_read_b64_tr_b16 v[114:115], v5 offset:512
    s_waitcnt vmcnt(7) lgkmcnt(2)
    v_mfma_f32_32x32x16_bf16 v[44:59], v[108:111], v[28:31], v[44:59]
    v_mfma_f32_32x32x16_bf16 v[92:107], v[108:111], v[120:123], v[92:107]
    ds_read_b64_tr_b16 v[116:117], v6 offset:0
    ds_read_b64_tr_b16 v[118:119], v6 offset:512
    s_waitcnt lgkmcnt(2)
    v_mfma_f32_32x32x16_bf16 v[60:75], v[112:115], v[28:31], v[60:75]
    ds_read_b64_tr_b16 v[108:109], v4 offset:3072
    ds_read_b64_tr_b16 v[110:111], v4 offset:3584
    s_waitcnt lgkmcnt(2)
    v_mfma_f32_32x32x16_bf16 v[76:91], v[116:119], v[28:31], v[76:91]
    ds_read_b64_tr_b16 v[112:113], v5 offset:3072
    ds_read_b64_tr_b16 v[114:115], v5 offset:3584
    s_add_u32 s22, s38, 28672
    buffer_load_dwordx4 v[28:31], v2, s[8:11], s22 offen sc1
    s_waitcnt vmcnt(7) lgkmcnt(2)
    v_mfma_f32_32x32x16_bf16 v[44:59], v[108:111], v[32:35], v[44:59]
    v_mfma_f32_32x32x16_bf16 v[92:107], v[108:111], v[120:123], v[92:107]
    ds_read_b64_tr_b16 v[116:117], v6 offset:3072
    ds_read_b64_tr_b16 v[118:119], v6 offset:3584
    s_waitcnt lgkmcnt(2)
    v_mfma_f32_32x32x16_bf16 v[60:75], v[112:115], v[32:35], v[60:75]
    ds_read_b64_tr_b16 v[108:109], v4 offset:6144
    ds_read_b64_tr_b16 v[110:111], v4 offset:6656
    s_waitcnt lgkmcnt(2)
    v_mfma_f32_32x32x16_bf16 v[76:91], v[116:119], v[32:35], v[76:91]
    ds_read_b64_tr_b16 v[112:113], v5 offset:6144
    ds_read_b64_tr_b16 v[114:115], v5 offset:6656
    s_add_u32 s22, s38, 29696
    buffer_load_dwordx4 v[32:35], v2, s[8:11], s22 offen sc1
    s_waitcnt vmcnt(7) lgkmcnt(2)
    v_mfma_f32_32x32x16_bf16 v[44:59], v[108:111], v[36:39], v[44:59]
    v_mfma_f32_32x32x16_bf16 v[92:107], v[108:111], v[120:123], v[92:107]
    ds_read_b64_tr_b16 v[116:117], v6 offset:6144
    ds_read_b64_tr_b16 v[118:119], v6 offset:6656
    s_waitcnt lgkmcnt(2)
    v_mfma_f32_32x32x16_bf16 v[60:75], v[112:115], v[36:39], v[60:75]
    ds_read_b64_tr_b16 v[108:109], v4 offset:9216
    ds_read_b64_tr_b16 v[110:111], v4 offset:9728
    s_waitcnt lgkmcnt(2)
    v_mfma_f32_32x32x16_bf16 v[76:91], v[116:119], v[36:39], v[76:91]
    ds_read_b64_tr_b16 v[112:113], v5 offset:9216
    ds_read_b64_tr_b16 v[114:115], v5 offset:9728
    s_add_u32 s22, s38, 30720
    buffer_load_dwordx4 v[36:39], v2, s[8:11], s22 offen sc1
    s_waitcnt vmcnt(7) lgkmcnt(2)
    v_mfma_f32_32x32x16_bf16 v[44:59], v[108:111], v[40:43], v[44:59]
    v_mfma_f32_32x32x16_bf16 v[92:107], v[108:111], v[120:123], v[92:107]
    ds_read_b64_tr_b16 v[116:117], v6 offset:9216
    ds_read_b64_tr_b16 v[118:119], v6 offset:9728
    s_waitcnt lgkmcnt(2)
    v_mfma_f32_32x32x16_bf16 v[60:75], v[112:115], v[40:43], v[60:75]
    s_waitcnt lgkmcnt(0)
    v_mfma_f32_32x32x16_bf16 v[76:91], v[116:119], v[40:43], v[76:91]
    s_add_u32 s22, s38, 31744
    buffer_load_dwordx4 v[40:43], v2, s[8:11], s22 offen sc1
    s_waitcnt vmcnt(19)
    s_barrier
    ds_read_b64_tr_b16 v[108:109], v4 offset:12288
    ds_read_b64_tr_b16 v[110:111], v4 offset:12800
    ds_read_b64_tr_b16 v[112:113], v5 offset:12288
    ds_read_b64_tr_b16 v[114:115], v5 offset:12800
    s_waitcnt vmcnt(7) lgkmcnt(2)
    v_mfma_f32_32x32x16_bf16 v[44:59], v[108:111], v[12:15], v[44:59]
    v_mfma_f32_32x32x16_bf16 v[92:107], v[108:111], v[120:123], v[92:107]
    ds_read_b64_tr_b16 v[116:117], v6 offset:12288
    ds_read_b64_tr_b16 v[118:119], v6 offset:12800
    s_waitcnt lgkmcnt(2)
    v_mfma_f32_32x32x16_bf16 v[60:75], v[112:115], v[12:15], v[60:75]
    ds_read_b64_tr_b16 v[108:109], v4 offset:15360
    ds_read_b64_tr_b16 v[110:111], v4 offset:15872
    s_waitcnt lgkmcnt(2)
    v_mfma_f32_32x32x16_bf16 v[76:91], v[116:119], v[12:15], v[76:91]
    ds_read_b64_tr_b16 v[112:113], v5 offset:15360
    ds_read_b64_tr_b16 v[114:115], v5 offset:15872
    s_waitcnt vmcnt(6) lgkmcnt(2)
    v_mfma_f32_32x32x16_bf16 v[44:59], v[108:111], v[16:19], v[44:59]
    v_mfma_f32_32x32x16_bf16 v[92:107], v[108:111], v[120:123], v[92:107]
    ds_read_b64_tr_b16 v[116:117], v6 offset:15360
    ds_read_b64_tr_b16 v[118:119], v6 offset:15872
    s_waitcnt lgkmcnt(2)
    v_mfma_f32_32x32x16_bf16 v[60:75], v[112:115], v[16:19], v[60:75]
    ds_read_b64_tr_b16 v[108:109], v4 offset:18432
    ds_read_b64_tr_b16 v[110:111], v4 offset:18944
    s_waitcnt lgkmcnt(2)
    v_mfma_f32_32x32x16_bf16 v[76:91], v[116:119], v[16:19], v[76:91]
    ds_read_b64_tr_b16 v[112:113], v5 offset:18432
    ds_read_b64_tr_b16 v[114:115], v5 offset:18944
    s_waitcnt vmcnt(5) lgkmcnt(2)
    v_mfma_f32_32x32x16_bf16 v[44:59], v[108:111], v[20:23], v[44:59]
    v_mfma_f32_32x32x16_bf16 v[92:107], v[108:111], v[120:123], v[92:107]
    ds_read_b64_tr_b16 v[116:117], v6 offset:18432
    ds_read_b64_tr_b16 v[118:119], v6 offset:18944
    s_waitcnt lgkmcnt(2)
    v_mfma_f32_32x32x16_bf16 v[60:75], v[112:115], v[20:23], v[60:75]
    ds_read_b64_tr_b16 v[108:109], v4 offset:21504
    ds_read_b64_tr_b16 v[110:111], v4 offset:22016
    s_waitcnt lgkmcnt(2)
    v_mfma_f32_32x32x16_bf16 v[76:91], v[116:119], v[20:23], v[76:91]
    ds_read_b64_tr_b16 v[112:113], v5 offset:21504
    ds_read_b64_tr_b16 v[114:115], v5 offset:22016
    s_waitcnt vmcnt(4) lgkmcnt(2)
    v_mfma_f32_32x32x16_bf16 v[44:59], v[108:111], v[24:27], v[44:59]
    v_mfma_f32_32x32x16_bf16 v[92:107], v[108:111], v[120:123], v[92:107]
    ds_read_b64_tr_b16 v[116:117], v6 offset:21504
    ds_read_b64_tr_b16 v[118:119], v6 offset:22016
    s_waitcnt lgkmcnt(2)
    v_mfma_f32_32x32x16_bf16 v[60:75], v[112:115], v[24:27], v[60:75]
    s_waitcnt lgkmcnt(0)
    v_mfma_f32_32x32x16_bf16 v[76:91], v[116:119], v[24:27], v[76:91]
    s_waitcnt vmcnt(12)
    s_barrier
    ds_read_b64_tr_b16 v[108:109], v4 offset:24576
    ds_read_b64_tr_b16 v[110:111], v4 offset:25088
    ds_read_b64_tr_b16 v[112:113], v5 offset:24576
    ds_read_b64_tr_b16 v[114:115], v5 offset:25088
    s_waitcnt vmcnt(3) lgkmcnt(2)
    v_mfma_f32_32x32x16_bf16 v[44:59], v[108:111], v[28:31], v[44:59]
    v_mfma_f32_32x32x16_bf16 v[92:107], v[108:111], v[120:123], v[92:107]
    ds_read_b64_tr_b16 v[116:117], v6 offset:24576
    ds_read_b64_tr_b16 v[118:119], v6 offset:25088
    s_waitcnt lgkmcnt(2)
    v_mfma_f32_32x32x16_bf16 v[60:75], v[112:115], v[28:31], v[60:75]
    ds_read_b64_tr_b16 v[108:109], v4 offset:27648
    ds_read_b64_tr_b16 v[110:111], v4 offset:28160
    s_waitcnt lgkmcnt(2)
    v_mfma_f32_32x32x16_bf16 v[76:91], v[116:119], v[28:31], v[76:91]
    ds_read_b64_tr_b16 v[112:113], v5 offset:27648
    ds_read_b64_tr_b16 v[114:115], v5 offset:28160
    s_waitcnt vmcnt(2) lgkmcnt(2)
    v_mfma_f32_32x32x16_bf16 v[44:59], v[108:111], v[32:35], v[44:59]
    v_mfma_f32_32x32x16_bf16 v[92:107], v[108:111], v[120:123], v[92:107]
    ds_read_b64_tr_b16 v[116:117], v6 offset:27648
    ds_read_b64_tr_b16 v[118:119], v6 offset:28160
    s_waitcnt lgkmcnt(2)
    v_mfma_f32_32x32x16_bf16 v[60:75], v[112:115], v[32:35], v[60:75]
    ds_read_b64_tr_b16 v[108:109], v4 offset:30720
    ds_read_b64_tr_b16 v[110:111], v4 offset:31232
    s_waitcnt lgkmcnt(2)
    v_mfma_f32_32x32x16_bf16 v[76:91], v[116:119], v[32:35], v[76:91]
    ds_read_b64_tr_b16 v[112:113], v5 offset:30720
    ds_read_b64_tr_b16 v[114:115], v5 offset:31232
    s_waitcnt vmcnt(1) lgkmcnt(2)
    v_mfma_f32_32x32x16_bf16 v[44:59], v[108:111], v[36:39], v[44:59]
    v_mfma_f32_32x32x16_bf16 v[92:107], v[108:111], v[120:123], v[92:107]
    ds_read_b64_tr_b16 v[116:117], v6 offset:30720
    ds_read_b64_tr_b16 v[118:119], v6 offset:31232
    s_waitcnt lgkmcnt(2)
    v_mfma_f32_32x32x16_bf16 v[60:75], v[112:115], v[36:39], v[60:75]
    ds_read_b64_tr_b16 v[108:109], v4 offset:33792
    ds_read_b64_tr_b16 v[110:111], v4 offset:34304
    s_waitcnt lgkmcnt(2)
    v_mfma_f32_32x32x16_bf16 v[76:91], v[116:119], v[36:39], v[76:91]
    ds_read_b64_tr_b16 v[112:113], v5 offset:33792
    ds_read_b64_tr_b16 v[114:115], v5 offset:34304
    s_waitcnt vmcnt(0) lgkmcnt(2)
    v_mfma_f32_32x32x16_bf16 v[44:59], v[108:111], v[40:43], v[44:59]
    v_mfma_f32_32x32x16_bf16 v[92:107], v[108:111], v[120:123], v[92:107]
    ds_read_b64_tr_b16 v[116:117], v6 offset:33792
    ds_read_b64_tr_b16 v[118:119], v6 offset:34304
    s_waitcnt lgkmcnt(2)
    v_mfma_f32_32x32x16_bf16 v[60:75], v[112:115], v[40:43], v[60:75]
    s_waitcnt lgkmcnt(0)
    v_mfma_f32_32x32x16_bf16 v[76:91], v[116:119], v[40:43], v[76:91]
    s_lshl_b32 s22, s34, 7
    s_add_u32 s22, s22, 61440
    v_lshrrev_b32 v10, 5, v1
    v_lshl_add_u32 v8, v10, 4, s22
    s_nop 7
    s_nop 1
    s_cmp_eq_u32 s16, 3
    s_cbranch_scc1 K1C2_nocs
    s_mov_b32 exec_lo, 1
    s_mov_b32 exec_hi, 1
    ds_write_b128 v8, v[92:95] offset:0
    ds_write_b128 v8, v[96:99] offset:32
    ds_write_b128 v8, v[100:103] offset:64
    ds_write_b128 v8, v[104:107] offset:96
    s_mov_b64 exec, -1
K1C2_nocs:
    s_waitcnt lgkmcnt(0)
    s_barrier
    v_mov_b32 v118, 0xc0135761
    v_mov_b32 v119, v118
    v_mov_b32 v120, 0xbdd2d3e8
    v_mov_b32 v121, v120
    v_mov_b32 v122, 1.0
    v_mov_b32 v123, 1.0
    v_lshlrev_b32 v10, 4, v10
    s_lshl_b32 s22, s34, 7
    s_add_u32 s22, s22, 61440
    v_add_u32 v8, s22, v10
    ds_read_b128 v[92:95], v8 offset:0
    ds_read_b128 v[96:99], v8 offset:32
    ds_read_b128 v[100:103], v8 offset:64
    ds_read_b128 v[104:107], v8 offset:96
    s_waitcnt lgkmcnt(0)
    v_pk_mul_f32 v[44:45], v[44:45], v[124:125] op_sel_hi:[1,0]
    v_pk_mul_f32 v[46:47], v[46:47], v[124:125] op_sel_hi:[1,0]
    v_pk_mul_f32 v[48:49], v[48:49], v[124:125] op_sel_hi:[1,0]
    v_pk_mul_f32 v[50:51], v[50:51], v[124:125] op_sel_hi:[1,0]
    v_pk_mul_f32 v[52:53], v[52:53], v[124:125] op_sel_hi:[1,0]
    v_pk_mul_f32 v[54:55], v[54:55], v[124:125] op_sel_hi:[1,0]
    v_pk_mul_f32 v[56:57], v[56:57], v[124:125] op_sel_hi:[1,0]
    v_pk_mul_f32 v[58:59], v[58:59], v[124:125] op_sel_hi:[1,0]
    v_pk_fma_f32 v[44:45], v[92:93], v[124:125], v[44:45] op_sel:[0,1,0] op_sel_hi:[1,1,1]
    v_pk_fma_f32 v[46:47], v[94:95], v[124:125], v[46:47] op_sel:[0,1,0] op_sel_hi:[1,1,1]
    v_pk_fma_f32 v[48:49], v[96:97], v[124:125], v[48:49] op_sel:[0,1,0] op_sel_hi:[1,1,1]
    v_pk_fma_f32 v[50:51], v[98:99], v[124:125], v[50:51] op_sel:[0,1,0] op_sel_hi:[1,1,1]
    v_pk_fma_f32 v[52:53], v[100:101], v[124:125], v[52:53] op_sel:[0,1,0] op_sel_hi:[1,1,1]
    v_pk_fma_f32 v[54:55], v[102:103], v[124:125], v[54:55] op_sel:[0,1,0] op_sel_hi:[1,1,1]
    v_pk_fma_f32 v[56:57], v[104:105], v[124:125], v[56:57] op_sel:[0,1,0] op_sel_hi:[1,1,1]
    v_pk_fma_f32 v[58:59], v[106:107], v[124:125], v[58:59] op_sel:[0,1,0] op_sel_hi:[1,1,1]
    v_pk_mul_f32 v[12:13], v[44:45], v[44:45]
    v_pk_mul_f32 v[14:15], v[46:47], v[46:47]
    v_pk_mul_f32 v[16:17], v[48:49], v[48:49]
    v_pk_mul_f32 v[18:19], v[50:51], v[50:51]
    v_pk_fma_f32 v[12:13], v[12:13], v[120:121], v[118:119]
    v_pk_fma_f32 v[14:15], v[14:15], v[120:121], v[118:119]
    v_pk_fma_f32 v[16:17], v[16:17], v[120:121], v[118:119]
    v_pk_fma_f32 v[18:19], v[18:19], v[120:121], v[118:119]
    v_pk_mul_f32 v[12:13], v[12:13], v[44:45]
    v_pk_mul_f32 v[14:15], v[14:15], v[46:47]
    v_pk_mul_f32 v[16:17], v[16:17], v[48:49]
    v_pk_mul_f32 v[18:19], v[18:19], v[50:51]
    v_exp_f32 v12, v12
    v_exp_f32 v14, v14
    v_exp_f32 v16, v16
    v_exp_f32 v18, v18
    v_exp_f32 v13, v13
    v_exp_f32 v15, v15
    v_exp_f32 v17, v17
    v_exp_f32 v19, v19
    v_pk_add_f32 v[12:13], v[12:13], v[122:123]
    v_pk_add_f32 v[14:15], v[14:15], v[122:123]
    v_pk_add_f32 v[16:17], v[16:17], v[122:123]
    v_pk_add_f32 v[18:19], v[18:19], v[122:123]
    v_rcp_f32 v12, v12
    v_rcp_f32 v14, v14
    v_rcp_f32 v16, v16
    v_rcp_f32 v18, v18
    v_rcp_f32 v13, v13
    v_rcp_f32 v15, v15
    v_rcp_f32 v17, v17
    v_rcp_f32 v19, v19
    v_pk_mul_f32 v[44:45], v[44:45], v[12:13]
    v_pk_mul_f32 v[46:47], v[46:47], v[14:15]
    v_pk_mul_f32 v[48:49], v[48:49], v[16:17]
    v_pk_mul_f32 v[50:51], v[50:51], v[18:19]
    v_pk_mul_f32 v[12:13], v[52:53], v[52:53]
    v_pk_mul_f32 v[14:15], v[54:55], v[54:55]
    v_pk_mul_f32 v[16:17], v[56:57], v[56:57]
    v_pk_mul_f32 v[18:19], v[58:59], v[58:59]
    v_pk_fma_f32 v[12:13], v[12:13], v[120:121], v[118:119]
    v_pk_fma_f32 v[14:15], v[14:15], v[120:121], v[118:119]
    v_pk_fma_f32 v[16:17], v[16:17], v[120:121], v[118:119]
    v_pk_fma_f32 v[18:19], v[18:19], v[120:121], v[118:119]
    v_pk_mul_f32 v[12:13], v[12:13], v[52:53]
    v_pk_mul_f32 v[14:15], v[14:15], v[54:55]
    v_pk_mul_f32 v[16:17], v[16:17], v[56:57]
    v_pk_mul_f32 v[18:19], v[18:19], v[58:59]
    v_exp_f32 v12, v12
    v_exp_f32 v14, v14
    v_exp_f32 v16, v16
    v_exp_f32 v18, v18
    v_exp_f32 v13, v13
    v_exp_f32 v15, v15
    v_exp_f32 v17, v17
    v_exp_f32 v19, v19
    v_pk_add_f32 v[12:13], v[12:13], v[122:123]
    v_pk_add_f32 v[14:15], v[14:15], v[122:123]
    v_pk_add_f32 v[16:17], v[16:17], v[122:123]
    v_pk_add_f32 v[18:19], v[18:19], v[122:123]
    v_rcp_f32 v12, v12
    v_rcp_f32 v14, v14
    v_rcp_f32 v16, v16
    v_rcp_f32 v18, v18
    v_rcp_f32 v13, v13
    v_rcp_f32 v15, v15
    v_rcp_f32 v17, v17
    v_rcp_f32 v19, v19
    v_pk_mul_f32 v[52:53], v[52:53], v[12:13]
    v_pk_mul_f32 v[54:55], v[54:55], v[14:15]
    v_pk_mul_f32 v[56:57], v[56:57], v[16:17]
    v_pk_mul_f32 v[58:59], v[58:59], v[18:19]
    v_cvt_pk_bf16_f32 v20, v44, v45
    v_cvt_pk_bf16_f32 v21, v46, v47
    v_cvt_pk_bf16_f32 v22, v48, v49
    v_cvt_pk_bf16_f32 v23, v50, v51
    v_cvt_pk_bf16_f32 v24, v52, v53
    v_cvt_pk_bf16_f32 v25, v54, v55
    v_cvt_pk_bf16_f32 v26, v56, v57
    v_cvt_pk_bf16_f32 v27, v58, v59
    s_mul_i32 s22, s40, 6
    s_lshl_b32 s23, s34, 1
    s_add_u32 s22, s22, s23
    s_cmp_ge_u32 s22, 86
    s_cbranch_scc1 K1C2_ns0
    s_mul_i32 s23, s37, 86
    s_add_u32 s22, s22, s23
    s_lshl_b32 s22, s22, 10
    s_add_u32 s22, s22, 0xc20000
    buffer_store_dwordx4 v[20:23], v2, s[8:11], s22 offen sc1
    buffer_store_dwordx4 v[24:27], v2, s[8:11], s22 offen offset:1024 sc1
K1C2_ns0:
    s_nop 1
    s_lshl_b32 s22, s35, 7
    s_add_u32 s22, s22, 61440
    v_add_u32 v8, s22, v10
    ds_read_b128 v[92:95], v8 offset:0
    ds_read_b128 v[96:99], v8 offset:32
    ds_read_b128 v[100:103], v8 offset:64
    ds_read_b128 v[104:107], v8 offset:96
    s_waitcnt lgkmcnt(0)
    v_pk_mul_f32 v[60:61], v[60:61], v[124:125] op_sel_hi:[1,0]
    v_pk_mul_f32 v[62:63], v[62:63], v[124:125] op_sel_hi:[1,0]
    v_pk_mul_f32 v[64:65], v[64:65], v[124:125] op_sel_hi:[1,0]
    v_pk_mul_f32 v[66:67], v[66:67], v[124:125] op_sel_hi:[1,0]
    v_pk_mul_f32 v[68:69], v[68:69], v[124:125] op_sel_hi:[1,0]
    v_pk_mul_f32 v[70:71], v[70:71], v[124:125] op_sel_hi:[1,0]
    v_pk_mul_f32 v[72:73], v[72:73], v[124:125] op_sel_hi:[1,0]
    v_pk_mul_f32 v[74:75], v[74:75], v[124:125] op_sel_hi:[1,0]
    v_pk_fma_f32 v[60:61], v[92:93], v[124:125], v[60:61] op_sel:[0,1,0] op_sel_hi:[1,1,1]
    v_pk_fma_f32 v[62:63], v[94:95], v[124:125], v[62:63] op_sel:[0,1,0] op_sel_hi:[1,1,1]
    v_pk_fma_f32 v[64:65], v[96:97], v[124:125], v[64:65] op_sel:[0,1,0] op_sel_hi:[1,1,1]
    v_pk_fma_f32 v[66:67], v[98:99], v[124:125], v[66:67] op_sel:[0,1,0] op_sel_hi:[1,1,1]
    v_pk_fma_f32 v[68:69], v[100:101], v[124:125], v[68:69] op_sel:[0,1,0] op_sel_hi:[1,1,1]
    v_pk_fma_f32 v[70:71], v[102:103], v[124:125], v[70:71] op_sel:[0,1,0] op_sel_hi:[1,1,1]
    v_pk_fma_f32 v[72:73], v[104:105], v[124:125], v[72:73] op_sel:[0,1,0] op_sel_hi:[1,1,1]
    v_pk_fma_f32 v[74:75], v[106:107], v[124:125], v[74:75] op_sel:[0,1,0] op_sel_hi:[1,1,1]
    v_pk_mul_f32 v[12:13], v[60:61], v[60:61]
    v_pk_mul_f32 v[14:15], v[62:63], v[62:63]
    v_pk_mul_f32 v[16:17], v[64:65], v[64:65]
    v_pk_mul_f32 v[18:19], v[66:67], v[66:67]
    v_pk_fma_f32 v[12:13], v[12:13], v[120:121], v[118:119]
    v_pk_fma_f32 v[14:15], v[14:15], v[120:121], v[118:119]
    v_pk_fma_f32 v[16:17], v[16:17], v[120:121], v[118:119]
    v_pk_fma_f32 v[18:19], v[18:19], v[120:121], v[118:119]
    v_pk_mul_f32 v[12:13], v[12:13], v[60:61]
    v_pk_mul_f32 v[14:15], v[14:15], v[62:63]
    v_pk_mul_f32 v[16:17], v[16:17], v[64:65]
    v_pk_mul_f32 v[18:19], v[18:19], v[66:67]
    v_exp_f32 v12, v12
    v_exp_f32 v14, v14
    v_exp_f32 v16, v16
    v_exp_f32 v18, v18
    v_exp_f32 v13, v13
    v_exp_f32 v15, v15
    v_exp_f32 v17, v17
    v_exp_f32 v19, v19
    v_pk_add_f32 v[12:13], v[12:13], v[122:123]
    v_pk_add_f32 v[14:15], v[14:15], v[122:123]
    v_pk_add_f32 v[16:17], v[16:17], v[122:123]
    v_pk_add_f32 v[18:19], v[18:19], v[122:123]
    v_rcp_f32 v12, v12
    v_rcp_f32 v14, v14
    v_rcp_f32 v16, v16
    v_rcp_f32 v18, v18
    v_rcp_f32 v13, v13
    v_rcp_f32 v15, v15
    v_rcp_f32 v17, v17
    v_rcp_f32 v19, v19
    v_pk_mul_f32 v[60:61], v[60:61], v[12:13]
    v_pk_mul_f32 v[62:63], v[62:63], v[14:15]
    v_pk_mul_f32 v[64:65], v[64:65], v[16:17]
    v_pk_mul_f32 v[66:67], v[66:67], v[18:19]
    v_pk_mul_f32 v[12:13], v[68:69], v[68:69]
    v_pk_mul_f32 v[14:15], v[70:71], v[70:71]
    v_pk_mul_f32 v[16:17], v[72:73], v[72:73]
    v_pk_mul_f32 v[18:19], v[74:75], v[74:75]
    v_pk_fma_f32 v[12:13], v[12:13], v[120:121], v[118:119]
    v_pk_fma_f32 v[14:15], v[14:15], v[120:121], v[118:119]
    v_pk_fma_f32 v[16:17], v[16:17], v[120:121], v[118:119]
    v_pk_fma_f32 v[18:19], v[18:19], v[120:121], v[118:119]
    v_pk_mul_f32 v[12:13], v[12:13], v[68:69]
    v_pk_mul_f32 v[14:15], v[14:15], v[70:71]
    v_pk_mul_f32 v[16:17], v[16:17], v[72:73]
    v_pk_mul_f32 v[18:19], v[18:19], v[74:75]
    v_exp_f32 v12, v12
    v_exp_f32 v14, v14
    v_exp_f32 v16, v16
    v_exp_f32 v18, v18
    v_exp_f32 v13, v13
    v_exp_f32 v15, v15
    v_exp_f32 v17, v17
    v_exp_f32 v19, v19
    v_pk_add_f32 v[12:13], v[12:13], v[122:123]
    v_pk_add_f32 v[14:15], v[14:15], v[122:123]
    v_pk_add_f32 v[16:17], v[16:17], v[122:123]
    v_pk_add_f32 v[18:19], v[18:19], v[122:123]
    v_rcp_f32 v12, v12
    v_rcp_f32 v14, v14
    v_rcp_f32 v16, v16
    v_rcp_f32 v18, v18
    v_rcp_f32 v13, v13
    v_rcp_f32 v15, v15
    v_rcp_f32 v17, v17
    v_rcp_f32 v19, v19
    v_pk_mul_f32 v[68:69], v[68:69], v[12:13]
    v_pk_mul_f32 v[70:71], v[70:71], v[14:15]
    v_pk_mul_f32 v[72:73], v[72:73], v[16:17]
    v_pk_mul_f32 v[74:75], v[74:75], v[18:19]
    v_cvt_pk_bf16_f32 v20, v60, v61
    v_cvt_pk_bf16_f32 v21, v62, v63
    v_cvt_pk_bf16_f32 v22, v64, v65
    v_cvt_pk_bf16_f32 v23, v66, v67
    v_cvt_pk_bf16_f32 v24, v68, v69
    v_cvt_pk_bf16_f32 v25, v70, v71
    v_cvt_pk_bf16_f32 v26, v72, v73
    v_cvt_pk_bf16_f32 v27, v74, v75
    s_mul_i32 s22, s40, 6
    s_lshl_b32 s23, s35, 1
    s_add_u32 s22, s22, s23
    s_cmp_ge_u32 s22, 86
    s_cbranch_scc1 K1C2_ns1
    s_mul_i32 s23, s37, 86
    s_add_u32 s22, s22, s23
    s_lshl_b32 s22, s22, 10
    s_add_u32 s22, s22, 0xc20000
    buffer_store_dwordx4 v[20:23], v2, s[8:11], s22 offen sc1
    buffer_store_dwordx4 v[24:27], v2, s[8:11], s22 offen offset:1024 sc1
K1C2_ns1:
    s_nop 1
    s_lshl_b32 s22, s36, 7
    s_add_u32 s22, s22, 61440
    v_add_u32 v8, s22, v10
    ds_read_b128 v[92:95], v8 offset:0
    ds_read_b128 v[96:99], v8 offset:32
    ds_read_b128 v[100:103], v8 offset:64
    ds_read_b128 v[104:107], v8 offset:96
    s_waitcnt lgkmcnt(0)
    v_pk_mul_f32 v[76:77], v[76:77], v[124:125] op_sel_hi:[1,0]
    v_pk_mul_f32 v[78:79], v[78:79], v[124:125] op_sel_hi:[1,0]
    v_pk_mul_f32 v[80:81], v[80:81], v[124:125] op_sel_hi:[1,0]
    v_pk_mul_f32 v[82:83], v[82:83], v[124:125] op_sel_hi:[1,0]
    v_pk_mul_f32 v[84:85], v[84:85], v[124:125] op_sel_hi:[1,0]
    v_pk_mul_f32 v[86:87], v[86:87], v[124:125] op_sel_hi:[1,0]
    v_pk_mul_f32 v[88:89], v[88:89], v[124:125] op_sel_hi:[1,0]
    v_pk_mul_f32 v[90:91], v[90:91], v[124:125] op_sel_hi:[1,0]
    v_pk_fma_f32 v[76:77], v[92:93], v[124:125], v[76:77] op_sel:[0,1,0] op_sel_hi:[1,1,1]
    v_pk_fma_f32 v[78:79], v[94:95], v[124:125], v[78:79] op_sel:[0,1,0] op_sel_hi:[1,1,1]
    v_pk_fma_f32 v[80:81], v[96:97], v[124:125], v[80:81] op_sel:[0,1,0] op_sel_hi:[1,1,1]
    v_pk_fma_f32 v[82:83], v[98:99], v[124:125], v[82:83] op_sel:[0,1,0] op_sel_hi:[1,1,1]
    v_pk_fma_f32 v[84:85], v[100:101], v[124:125], v[84:85] op_sel:[0,1,0] op_sel_hi:[1,1,1]
    v_pk_fma_f32 v[86:87], v[102:103], v[124:125], v[86:87] op_sel:[0,1,0] op_sel_hi:[1,1,1]
    v_pk_fma_f32 v[88:89], v[104:105], v[124:125], v[88:89] op_sel:[0,1,0] op_sel_hi:[1,1,1]
    v_pk_fma_f32 v[90:91], v[106:107], v[124:125], v[90:91] op_sel:[0,1,0] op_sel_hi:[1,1,1]
    v_pk_mul_f32 v[12:13], v[76:77], v[76:77]
    v_pk_mul_f32 v[14:15], v[78:79], v[78:79]
    v_pk_mul_f32 v[16:17], v[80:81], v[80:81]
    v_pk_mul_f32 v[18:19], v[82:83], v[82:83]
    v_pk_fma_f32 v[12:13], v[12:13], v[120:121], v[118:119]
    v_pk_fma_f32 v[14:15], v[14:15], v[120:121], v[118:119]
    v_pk_fma_f32 v[16:17], v[16:17], v[120:121], v[118:119]
    v_pk_fma_f32 v[18:19], v[18:19], v[120:121], v[118:119]
    v_pk_mul_f32 v[12:13], v[12:13], v[76:77]
    v_pk_mul_f32 v[14:15], v[14:15], v[78:79]
    v_pk_mul_f32 v[16:17], v[16:17], v[80:81]
    v_pk_mul_f32 v[18:19], v[18:19], v[82:83]
    v_exp_f32 v12, v12
    v_exp_f32 v14, v14
    v_exp_f32 v16, v16
    v_exp_f32 v18, v18
    v_exp_f32 v13, v13
    v_exp_f32 v15, v15
    v_exp_f32 v17, v17
    v_exp_f32 v19, v19
    v_pk_add_f32 v[12:13], v[12:13], v[122:123]
    v_pk_add_f32 v[14:15], v[14:15], v[122:123]
    v_pk_add_f32 v[16:17], v[16:17], v[122:123]
    v_pk_add_f32 v[18:19], v[18:19], v[122:123]
    v_rcp_f32 v12, v12
    v_rcp_f32 v14, v14
    v_rcp_f32 v16, v16
    v_rcp_f32 v18, v18
    v_rcp_f32 v13, v13
    v_rcp_f32 v15, v15
    v_rcp_f32 v17, v17
    v_rcp_f32 v19, v19
    v_pk_mul_f32 v[76:77], v[76:77], v[12:13]
    v_pk_mul_f32 v[78:79], v[78:79], v[14:15]
    v_pk_mul_f32 v[80:81], v[80:81], v[16:17]
    v_pk_mul_f32 v[82:83], v[82:83], v[18:19]
    v_pk_mul_f32 v[12:13], v[84:85], v[84:85]
    v_pk_mul_f32 v[14:15], v[86:87], v[86:87]
    v_pk_mul_f32 v[16:17], v[88:89], v[88:89]
    v_pk_mul_f32 v[18:19], v[90:91], v[90:91]
    v_pk_fma_f32 v[12:13], v[12:13], v[120:121], v[118:119]
    v_pk_fma_f32 v[14:15], v[14:15], v[120:121], v[118:119]
    v_pk_fma_f32 v[16:17], v[16:17], v[120:121], v[118:119]
    v_pk_fma_f32 v[18:19], v[18:19], v[120:121], v[118:119]
    v_pk_mul_f32 v[12:13], v[12:13], v[84:85]
    v_pk_mul_f32 v[14:15], v[14:15], v[86:87]
    v_pk_mul_f32 v[16:17], v[16:17], v[88:89]
    v_pk_mul_f32 v[18:19], v[18:19], v[90:91]
    v_exp_f32 v12, v12
    v_exp_f32 v14, v14
    v_exp_f32 v16, v16
    v_exp_f32 v18, v18
    v_exp_f32 v13, v13
    v_exp_f32 v15, v15
    v_exp_f32 v17, v17
    v_exp_f32 v19, v19
    v_pk_add_f32 v[12:13], v[12:13], v[122:123]
    v_pk_add_f32 v[14:15], v[14:15], v[122:123]
    v_pk_add_f32 v[16:17], v[16:17], v[122:123]
    v_pk_add_f32 v[18:19], v[18:19], v[122:123]
    v_rcp_f32 v12, v12
    v_rcp_f32 v14, v14
    v_rcp_f32 v16, v16
    v_rcp_f32 v18, v18
    v_rcp_f32 v13, v13
    v_rcp_f32 v15, v15
    v_rcp_f32 v17, v17
    v_rcp_f32 v19, v19
    v_pk_mul_f32 v[84:85], v[84:85], v[12:13]
    v_pk_mul_f32 v[86:87], v[86:87], v[14:15]
    v_pk_mul_f32 v[88:89], v[88:89], v[16:17]
    v_pk_mul_f32 v[90:91], v[90:91], v[18:19]
    v_cvt_pk_bf16_f32 v20, v76, v77
    v_cvt_pk_bf16_f32 v21, v78, v79
    v_cvt_pk_bf16_f32 v22, v80, v81
    v_cvt_pk_bf16_f32 v23, v82, v83
    v_cvt_pk_bf16_f32 v24, v84, v85
    v_cvt_pk_bf16_f32 v25, v86, v87
    v_cvt_pk_bf16_f32 v26, v88, v89
    v_cvt_pk_bf16_f32 v27, v90, v91
    s_mul_i32 s22, s40, 6
    s_lshl_b32 s23, s36, 1
    s_add_u32 s22, s22, s23
    s_cmp_ge_u32 s22, 86
    s_cbranch_scc1 K1C2_ns2
    s_mul_i32 s23, s37, 86
    s_add_u32 s22, s22, s23
    s_lshl_b32 s22, s22, 10
    s_add_u32 s22, s22, 0xc20000
    buffer_store_dwordx4 v[20:23], v2, s[8:11], s22 offen sc1
    buffer_store_dwordx4 v[24:27], v2, s[8:11], s22 offen offset:1024 sc1
K1C2_ns2:
    s_nop 1
    s_waitcnt vmcnt(0)
    s_barrier
    s_lshl_b32 s22, s39, 7
    s_lshl_b32 s23, s40, 2
    s_add_u32 s41, s22, s23
    s_add_u32 s41, s41, 0x1480800
    s_cmp_eq_u32 s16, 0
    s_cbranch_scc0 K1C2_end
    v_mov_b32 v8, 1
    v_mov_b32 v9, 0
    s_mov_b64 exec, 1
    buffer_store_dword v8, v9, s[8:11], s41 offen sc1
    s_mov_b64 exec, -1
K1C2_end:
    s_lshr_b32 s17, s16, 1
    s_and_b32 s18, s16, 1
    s_lshl_b32 s30, s16, 11
    v_lshrrev_b32 v8, 3, v1
    v_bfe_u32 v9, v1, 4, 1
    v_lshlrev_b32 v9, 2, v9
    v_and_b32 v10, 7, v1
    v_xor_b32 v9, v9, v10
    v_lshlrev_b32 v9, 4, v9
    v_lshl_add_u32 v3, v8, 10, v9
    s_lshl_b32 s22, s17, 10
    v_add_u32 v4, s22, v2
    v_lshrrev_b32 v8, 5, v1
    v_lshlrev_b32 v8, 9, v8
    v_bfe_u32 v9, v1, 2, 2
    v_lshl_add_u32 v8, v9, 7, v8
    v_lshrrev_b32 v9, 1, v9
    v_xor_b32 v9, s18, v9
    v_lshl_add_u32 v8, v9, 6, v8
    v_bfe_u32 v9, v1, 4, 1
    v_lshl_add_u32 v8, v9, 5, v8
    v_and_b32 v9, 3, v1
    v_lshl_add_u32 v8, v9, 3, v8
    v_add_u32 v5, 8192, v8
    s_and_b32 s22, s3, 7
    s_lshr_b32 s23, s3, 3
    s_and_b32 s19, s23, 3
    s_lshl_b32 s22, s22, 2
    s_add_u32 s19, s19, s22
    s_lshr_b32 s20, s23, 2
    s_lshl_b32 s31, s19, 1
    s_add_u32 s31, s31, s17
    s_lshl_b32 s32, s20, 2
    s_lshl_b32 s22, s18, 1
    s_add_u32 s32, s32, s22
    s_mov_b32 s12, s46
    s_mov_b32 s13, s47
    s_mov_b32 s14, 1409024
    s_lshr_b32 s22, s19, 1
    s_lshl_b32 s22, s22, 7
    s_add_u32 s41, s22, 0x1480800
    s_barrier
    s_cmp_eq_u32 s16, 0
    s_cbranch_scc0 K1C4f_wb
    v_min_u32 v8, 14, v1
    v_lshlrev_b32 v8, 2, v8
K1C4f_poll:
    buffer_load_dword v9, v8, s[8:11], s41 offen sc1
    s_waitcnt vmcnt(0)
    v_cmp_ne_u32 vcc, 1, v9
    s_nop 4
    s_cmp_eq_u64 vcc, 0
    s_cbranch_scc1 K1C4f_wb
    s_sleep 4
    s_branch K1C4f_poll
K1C4f_wb:
    s_barrier
    s_mov_b32 s26, s16
    s_lshl_b32 s22, s19, 1
    s_mul_i32 s27, s22, 88064
    s_add_u32 s27, s27, 0xc20000
    s_lshl_b32 s28, s20, 7
    s_mov_b32 s29, 85
    s_mov_b32 s25, 0
    s_mov_b32 s24, 0
    s_lshl_b32 s22, s31, 5
    s_add_u32 s22, s22, s32
    s_lshl_b32 s33, s22, 10
    s_add_u32 s22, s33, 0x820000
    buffer_load_dwordx4 v[60:63], v2, s[8:11], s22 offen sc1
    buffer_load_dwordx4 v[64:67], v2, s[8:11], s22 offen offset:1024 sc1
    s_min_u32 s22, s26, s29
    s_lshl_b32 s22, s22, 10
    s_add_u32 s22, s22, s27
    s_add_u32 m0, s25, s30
    s_nop 0
    buffer_load_dwordx4 v2, s[8:11], s22 offen sc1 lds
    s_add_u32 m0, m0, 1024
    s_add_u32 s22, s22, 88064
    buffer_load_dwordx4 v2, s[8:11], s22 offen sc1 lds
    s_add_u32 s22, s25, s30
    s_lshl_b32 s23, s26, 14
    s_add_u32 m0, s22, 8192
    s_add_u32 s23, s23, s28
    buffer_load_dwordx4 v3, s[12:15], s23 offen lds
    s_add_u32 m0, m0, 1024
    s_add_u32 s23, s23, 8192
    buffer_load_dwordx4 v3, s[12:15], s23 offen lds
    s_add_u32 s26, s26, 4
    s_add_u32 s25, s25, 16384
    s_cmp_eq_u32 s25, 81920
    s_cselect_b32 s25, 0, s25
    s_min_u32 s22, s26, s29
    s_lshl_b32 s22, s22, 10
    s_add_u32 s22, s22, s27
    s_add_u32 m0, s25, s30
    s_nop 0
    buffer_load_dwordx4 v2, s[8:11], s22 offen sc1 lds
    s_add_u32 m0, m0, 1024
    s_add_u32 s22, s22, 88064
    buffer_load_dwordx4 v2, s[8:11], s22 offen sc1 lds
    s_add_u32 s22, s25, s30
    s_lshl_b32 s23, s26, 14
    s_add_u32 m0, s22, 8192
    s_add_u32 s23, s23, s28
    buffer_load_dwordx4 v3, s[12:15], s23 offen lds
    s_add_u32 m0, m0, 1024
    s_add_u32 s23, s23, 8192
    buffer_load_dwordx4 v3, s[12:15], s23 offen lds
    s_add_u32 s26, s26, 4
    s_add_u32 s25, s25, 16384
    s_cmp_eq_u32 s25, 81920
    s_cselect_b32 s25, 0, s25
    s_min_u32 s22, s26, s29
    s_lshl_b32 s22, s22, 10
    s_add_u32 s22, s22, s27
    s_add_u32 m0, s25, s30
    s_nop 0
    buffer_load_dwordx4 v2, s[8:11], s22 offen sc1 lds
    s_add_u32 m0, m0, 1024
    s_add_u32 s22, s22, 88064
    buffer_load_dwordx4 v2, s[8:11], s22 offen sc1 lds
    s_add_u32 s22, s25, s30
    s_lshl_b32 s23, s26, 14
    s_add_u32 m0, s22, 8192
    s_add_u32 s23, s23, s28
    buffer_load_dwordx4 v3, s[12:15], s23 offen lds
    s_add_u32 m0, m0, 1024
    s_add_u32 s23, s23, 8192
    buffer_load_dwordx4 v3, s[12:15], s23 offen lds
    s_add_u32 s26, s26, 4
    s_add_u32 s25, s25, 16384
    s_cmp_eq_u32 s25, 81920
    s_cselect_b32 s25, 0, s25
    s_min_u32 s22, s26, s29
    s_lshl_b32 s22, s22, 10
    s_add_u32 s22, s22, s27
    s_add_u32 m0, s25, s30
    s_nop 0
    buffer_load_dwordx4 v2, s[8:11], s22 offen sc1 lds
    s_add_u32 m0, m0, 1024
    s_add_u32 s22, s22, 88064
    buffer_load_dwordx4 v2, s[8:11], s22 offen sc1 lds
    s_add_u32 s22, s25, s30
    s_lshl_b32 s23, s26, 14
    s_add_u32 m0, s22, 8192
    s_add_u32 s23, s23, s28
    buffer_load_dwordx4 v3, s[12:15], s23 offen lds
    s_add_u32 m0, m0, 1024
    s_add_u32 s23, s23, 8192
    buffer_load_dwordx4 v3, s[12:15], s23 offen lds
    s_add_u32 s26, s26, 4
    s_add_u32 s25, s25, 16384
    s_cmp_eq_u32 s25, 81920
    s_cselect_b32 s25, 0, s25
    s_waitcnt vmcnt(12)
    s_barrier
    v_add_u32 v6, s24, v4
    v_add_u32 v7, s24, v5
    ds_read_b128 v[12:15], v6 offset:0
    ds_read_b64_tr_b16 v[28:29], v7 offset:0
    ds_read_b64_tr_b16 v[30:31], v7 offset:1024
    ds_read_b128 v[16:19], v6 offset:2048
    ds_read_b64_tr_b16 v[32:33], v7 offset:2048
    ds_read_b64_tr_b16 v[34:35], v7 offset:3072
    s_min_u32 s22, s26, s29
    s_lshl_b32 s22, s22, 10
    s_add_u32 s22, s22, s27
    s_add_u32 m0, s25, s30
    s_nop 0
    buffer_load_dwordx4 v2, s[8:11], s22 offen sc1 lds
    s_add_u32 m0, m0, 1024
    s_add_u32 s22, s22, 88064
    buffer_load_dwordx4 v2, s[8:11], s22 offen sc1 lds
    s_add_u32 s22, s25, s30
    s_lshl_b32 s23, s26, 14
    s_add_u32 m0, s22, 8192
    s_add_u32 s23, s23, s28
    buffer_load_dwordx4 v3, s[12:15], s23 offen lds
    s_add_u32 m0, m0, 1024
    s_add_u32 s23, s23, 8192
    buffer_load_dwordx4 v3, s[12:15], s23 offen lds
    s_add_u32 s26, s26, 4
    s_add_u32 s25, s25, 16384
    s_cmp_eq_u32 s25, 81920
    s_cselect_b32 s25, 0, s25
    s_add_u32 s24, s24, 16384
    s_cmp_eq_u32 s24, 81920
    s_cselect_b32 s24, 0, s24
    s_waitcnt lgkmcnt(3)
    v_mfma_f32_32x32x16_bf16 v[44:59], v[28:31], v[12:15], 0
    ds_read_b128 v[12:15], v6 offset:4096
    ds_read_b64_tr_b16 v[28:29], v7 offset:4096
    ds_read_b64_tr_b16 v[30:31], v7 offset:5120
    s_waitcnt lgkmcnt(3)
    v_mfma_f32_32x32x16_bf16 v[44:59], v[32:35], v[16:19], v[44:59]
    ds_read_b128 v[16:19], v6 offset:6144
    ds_read_b64_tr_b16 v[32:33], v7 offset:6144
    ds_read_b64_tr_b16 v[34:35], v7 offset:7168
    s_waitcnt lgkmcnt(3)
    v_mfma_f32_32x32x16_bf16 v[44:59], v[28:31], v[12:15], v[44:59]
    s_waitcnt lgkmcnt(0)
    v_mfma_f32_32x32x16_bf16 v[44:59], v[32:35], v[16:19], v[44:59]
    s_mov_b32 s21, 17
.p2align 6
K1C4_loop:
    s_waitcnt vmcnt(12)
    s_barrier
    v_add_u32 v6, s24, v4
    v_add_u32 v7, s24, v5
    ds_read_b128 v[12:15], v6 offset:0
    ds_read_b64_tr_b16 v[28:29], v7 offset:0
    ds_read_b64_tr_b16 v[30:31], v7 offset:1024
    ds_read_b128 v[16:19], v6 offset:2048
    ds_read_b64_tr_b16 v[32:33], v7 offset:2048
    ds_read_b64_tr_b16 v[34:35], v7 offset:3072
    s_min_u32 s22, s26, s29
    s_lshl_b32 s22, s22, 10
    s_add_u32 s22, s22, s27
    s_add_u32 m0, s25, s30
    s_nop 0
    buffer_load_dwordx4 v2, s[8:11], s22 offen sc1 lds
    s_add_u32 m0, m0, 1024
    s_add_u32 s22, s22, 88064
    buffer_load_dwordx4 v2, s[8:11], s22 offen sc1 lds
    s_add_u32 s22, s25, s30
    s_lshl_b32 s23, s26, 14
    s_add_u32 m0, s22, 8192
    s_add_u32 s23, s23, s28
    buffer_load_dwordx4 v3, s[12:15], s23 offen lds
    s_add_u32 m0, m0, 1024
    s_add_u32 s23, s23, 8192
    buffer_load_dwordx4 v3, s[12:15], s23 offen lds
    s_add_u32 s26, s26, 4
    s_add_u32 s25, s25, 16384
    s_cmp_eq_u32 s25, 81920
    s_cselect_b32 s25, 0, s25
    s_add_u32 s24, s24, 16384
    s_cmp_eq_u32 s24, 81920
    s_cselect_b32 s24, 0, s24
    s_waitcnt lgkmcnt(3)
    v_mfma_f32_32x32x16_bf16 v[44:59], v[28:31], v[12:15], v[44:59]
    ds_read_b128 v[12:15], v6 offset:4096
    ds_read_b64_tr_b16 v[28:29], v7 offset:4096
    ds_read_b64_tr_b16 v[30:31], v7 offset:5120
    s_waitcnt lgkmcnt(3)
    v_mfma_f32_32x32x16_bf16 v[44:59], v[32:35], v[16:19], v[44:59]
    ds_read_b128 v[16:19], v6 offset:6144
    ds_read_b64_tr_b16 v[32:33], v7 offset:6144
    ds_read_b64_tr_b16 v[34:35], v7 offset:7168
    s_waitcnt lgkmcnt(3)
    v_mfma_f32_32x32x16_bf16 v[44:59], v[28:31], v[12:15], v[44:59]
    s_waitcnt lgkmcnt(0)
    v_mfma_f32_32x32x16_bf16 v[44:59], v[32:35], v[16:19], v[44:59]
    s_sub_u32 s21, s21, 1
    s_cmp_lg_u32 s21, 0
    s_cbranch_scc1 K1C4_loop
    s_load_dwordx2 s[42:43], s[0:1], 16
    s_load_dwordx2 s[44:45], s[0:1], 72
    s_lshl_b32 s34, s16, 15
    s_lshl_b32 s23, s20, 7
    s_add_u32 s34, s34, s23
    s_lshl_b32 s35, s16, 12
    s_waitcnt lgkmcnt(0)
    s_mov_b32 s36, s42
    s_mov_b32 s37, s43
    s_mov_b32 s38, 0x80000
    s_mov_b32 s39, 0x20000
    s_waitcnt vmcnt(12)
    s_barrier
    v_add_u32 v6, s24, v4
    v_add_u32 v7, s24, v5
    ds_read_b128 v[12:15], v6 offset:0
    ds_read_b64_tr_b16 v[28:29], v7 offset:0
    ds_read_b64_tr_b16 v[30:31], v7 offset:1024
    ds_read_b128 v[16:19], v6 offset:2048
    ds_read_b64_tr_b16 v[32:33], v7 offset:2048
    ds_read_b64_tr_b16 v[34:35], v7 offset:3072
    s_add_u32 m0, s35, 32768
    s_add_u32 s22, s34, 0
    buffer_load_dwordx4 v3, s[36:39], s22 offen lds
    s_add_u32 m0, m0, 1024
    s_add_u32 s22, s22, 8192
    buffer_load_dwordx4 v3, s[36:39], s22 offen lds
    s_add_u32 m0, m0, 1024
    s_add_u32 s22, s22, 8192
    buffer_load_dwordx4 v3, s[36:39], s22 offen lds
    s_add_u32 m0, m0, 1024
    s_add_u32 s22, s22, 8192
    buffer_load_dwordx4 v3, s[36:39], s22 offen lds
    s_add_u32 s24, s24, 16384
    s_cmp_eq_u32 s24, 81920
    s_cselect_b32 s24, 0, s24
    s_waitcnt lgkmcnt(3)
    v_mfma_f32_32x32x16_bf16 v[44:59], v[28:31], v[12:15], v[44:59]
    ds_read_b128 v[12:15], v6 offset:4096
    ds_read_b64_tr_b16 v[28:29], v7 offset:4096
    ds_read_b64_tr_b16 v[30:31], v7 offset:5120
    s_waitcnt lgkmcnt(3)
    v_mfma_f32_32x32x16_bf16 v[44:59], v[32:35], v[16:19], v[44:59]
    ds_read_b128 v[16:19], v6 offset:6144
    ds_read_b64_tr_b16 v[32:33], v7 offset:6144
    ds_read_b64_tr_b16 v[34:35], v7 offset:7168
    s_waitcnt lgkmcnt(3)
    v_mfma_f32_32x32x16_bf16 v[44:59], v[28:31], v[12:15], v[44:59]
    s_waitcnt lgkmcnt(0)
    v_mfma_f32_32x32x16_bf16 v[44:59], v[32:35], v[16:19], v[44:59]
    s_waitcnt vmcnt(12)
    s_barrier
    v_add_u32 v6, s24, v4
    v_add_u32 v7, s24, v5
    ds_read_b128 v[12:15], v6 offset:0
    ds_read_b64_tr_b16 v[28:29], v7 offset:0
    ds_read_b64_tr_b16 v[30:31], v7 offset:1024
    ds_read_b128 v[16:19], v6 offset:2048
    ds_read_b64_tr_b16 v[32:33], v7 offset:2048
    ds_read_b64_tr_b16 v[34:35], v7 offset:3072
    s_add_u32 m0, s35, 49152
    s_add_u32 s22, s34, 131072
    buffer_load_dwordx4 v3, s[36:39], s22 offen lds
    s_add_u32 m0, m0, 1024
    s_add_u32 s22, s22, 8192
    buffer_load_dwordx4 v3, s[36:39], s22 offen lds
    s_add_u32 m0, m0, 1024
    s_add_u32 s22, s22, 8192
    buffer_load_dwordx4 v3, s[36:39], s22 offen lds
    s_add_u32 m0, m0, 1024
    s_add_u32 s22, s22, 8192
    buffer_load_dwordx4 v3, s[36:39], s22 offen lds
    s_add_u32 s24, s24, 16384
    s_cmp_eq_u32 s24, 81920
    s_cselect_b32 s24, 0, s24
    s_waitcnt lgkmcnt(3)
    v_mfma_f32_32x32x16_bf16 v[44:59], v[28:31], v[12:15], v[44:59]
    ds_read_b128 v[12:15], v6 offset:4096
    ds_read_b64_tr_b16 v[28:29], v7 offset:4096
    ds_read_b64_tr_b16 v[30:31], v7 offset:5120
    s_waitcnt lgkmcnt(3)
    v_mfma_f32_32x32x16_bf16 v[44:59], v[32:35], v[16:19], v[44:59]
    ds_read_b128 v[16:19], v6 offset:6144
    ds_read_b64_tr_b16 v[32:33], v7 offset:6144
    ds_read_b64_tr_b16 v[34:35], v7 offset:7168
    s_waitcnt lgkmcnt(3)
    v_mfma_f32_32x32x16_bf16 v[44:59], v[28:31], v[12:15], v[44:59]
    s_waitcnt lgkmcnt(0)
    v_mfma_f32_32x32x16_bf16 v[44:59], v[32:35], v[16:19], v[44:59]
    s_waitcnt vmcnt(12)
    s_barrier
    v_add_u32 v6, s24, v4
    v_add_u32 v7, s24, v5
    ds_read_b128 v[12:15], v6 offset:0
    ds_read_b64_tr_b16 v[28:29], v7 offset:0
    ds_read_b64_tr_b16 v[30:31], v7 offset:1024
    ds_read_b128 v[16:19], v6 offset:2048
    ds_read_b64_tr_b16 v[32:33], v7 offset:2048
    ds_read_b64_tr_b16 v[34:35], v7 offset:3072
    s_add_u32 m0, s35, 65536
    s_add_u32 s22, s34, 262144
    buffer_load_dwordx4 v3, s[36:39], s22 offen lds
    s_add_u32 m0, m0, 1024
    s_add_u32 s22, s22, 8192
    buffer_load_dwordx4 v3, s[36:39], s22 offen lds
    s_add_u32 m0, m0, 1024
    s_add_u32 s22, s22, 8192
    buffer_load_dwordx4 v3, s[36:39], s22 offen lds
    s_add_u32 m0, m0, 1024
    s_add_u32 s22, s22, 8192
    buffer_load_dwordx4 v3, s[36:39], s22 offen lds
    s_add_u32 s24, s24, 16384
    s_cmp_eq_u32 s24, 81920
    s_cselect_b32 s24, 0, s24
    s_waitcnt lgkmcnt(3)
    v_mfma_f32_32x32x16_bf16 v[44:59], v[28:31], v[12:15], v[44:59]
    ds_read_b128 v[12:15], v6 offset:4096
    ds_read_b64_tr_b16 v[28:29], v7 offset:4096
    ds_read_b64_tr_b16 v[30:31], v7 offset:5120
    s_waitcnt lgkmcnt(3)
    v_mfma_f32_32x32x16_bf16 v[44:59], v[32:35], v[16:19], v[44:59]
    ds_read_b128 v[16:19], v6 offset:6144
    ds_read_b64_tr_b16 v[32:33], v7 offset:6144
    ds_read_b64_tr_b16 v[34:35], v7 offset:7168
    s_waitcnt lgkmcnt(3)
    v_mfma_f32_32x32x16_bf16 v[44:59], v[28:31], v[12:15], v[44:59]
    s_waitcnt lgkmcnt(0)
    v_mfma_f32_32x32x16_bf16 v[44:59], v[32:35], v[16:19], v[44:59]
    s_waitcnt vmcnt(12)
    s_barrier
    v_add_u32 v6, s24, v4
    v_add_u32 v7, s24, v5
    ds_read_b128 v[12:15], v6 offset:0
    ds_read_b64_tr_b16 v[28:29], v7 offset:0
    ds_read_b64_tr_b16 v[30:31], v7 offset:1024
    ds_read_b128 v[16:19], v6 offset:2048
    ds_read_b64_tr_b16 v[32:33], v7 offset:2048
    ds_read_b64_tr_b16 v[34:35], v7 offset:3072
    s_add_u32 m0, s35, 0
    s_add_u32 s22, s34, 393216
    buffer_load_dwordx4 v3, s[36:39], s22 offen lds
    s_add_u32 m0, m0, 1024
    s_add_u32 s22, s22, 8192
    buffer_load_dwordx4 v3, s[36:39], s22 offen lds
    s_add_u32 m0, m0, 1024
    s_add_u32 s22, s22, 8192
    buffer_load_dwordx4 v3, s[36:39], s22 offen lds
    s_add_u32 m0, m0, 1024
    s_add_u32 s22, s22, 8192
    buffer_load_dwordx4 v3, s[36:39], s22 offen lds
    s_add_u32 s24, s24, 16384
    s_cmp_eq_u32 s24, 81920
    s_cselect_b32 s24, 0, s24
    s_waitcnt lgkmcnt(3)
    v_mfma_f32_32x32x16_bf16 v[44:59], v[28:31], v[12:15], v[44:59]
    s_waitcnt lgkmcnt(0)
    v_mfma_f32_32x32x16_bf16 v[44:59], v[32:35], v[16:19], v[44:59]
    s_nop 7
    s_nop 3
    v_lshlrev_b32 v20, 16, v60
    v_and_b32 v21, 0xffff0000, v60
    v_lshlrev_b32 v22, 16, v61
    v_and_b32 v23, 0xffff0000, v61
    v_lshlrev_b32 v24, 16, v62
    v_and_b32 v25, 0xffff0000, v62
    v_lshlrev_b32 v26, 16, v63
    v_and_b32 v27, 0xffff0000, v63
    v_lshlrev_b32 v28, 16, v64
    v_and_b32 v29, 0xffff0000, v64
    v_lshlrev_b32 v30, 16, v65
    v_and_b32 v31, 0xffff0000, v65
    v_lshlrev_b32 v32, 16, v66
    v_and_b32 v33, 0xffff0000, v66
    v_lshlrev_b32 v34, 16, v67
    v_and_b32 v35, 0xffff0000, v67
    v_pk_add_f32 v[44:45], v[44:45], v[20:21]
    v_pk_add_f32 v[46:47], v[46:47], v[22:23]
    v_pk_add_f32 v[48:49], v[48:49], v[24:25]
    v_pk_add_f32 v[50:51], v[50:51], v[26:27]
    v_pk_add_f32 v[52:53], v[52:53], v[28:29]
    v_pk_add_f32 v[54:55], v[54:55], v[30:31]
    v_pk_add_f32 v[56:57], v[56:57], v[32:33]
    v_pk_add_f32 v[58:59], v[58:59], v[34:35]
    s_barrier
    s_lshl_b32 s22, s16, 12
    s_add_u32 s22, s22, 16384
    v_add_u32 v10, s22, v2
    ds_write_b128 v10, v[44:47] offset:0
    ds_write_b128 v10, v[48:51] offset:1024
    ds_write_b128 v10, v[52:55] offset:2048
    ds_write_b128 v10, v[56:59] offset:3072
    s_mov_b32 s52, s44
    s_mov_b32 s53, s45
    s_mov_b32 s54, 0x200000
    s_mov_b32 s55, 0x20000
    v_and_b32 v8, 31, v1
    v_lshlrev_b32 v8, 2, v8
    s_lshl_b32 s23, s31, 7
    s_add_u32 s23, s23, 0x1468000
    buffer_load_dword v126, v8, s[8:11], s23 offen
    v_subrev_u32 v8, 8192, v5
    v_xor_b32 v9, 64, v8
    s_cmp_eq_u32 s18, 0
    s_cselect_b32 s22, 32768, 0
    s_cselect_b32 s23, 49152, 0
    s_cbranch_scc1 K1CF_k0
    s_mov_b32 s22, 65536
    s_mov_b32 s23, 0
    v_add_u32 v125, s22, v8
    v_add_u32 v124, s22, v9
    v_add_u32 v6, s23, v8
    v_add_u32 v4, s23, v9
    s_branch K1CF_k1
K1CF_k0:
    v_add_u32 v124, s22, v8
    v_add_u32 v125, s22, v9
    v_add_u32 v4, s23, v8
    v_add_u32 v6, s23, v9
K1CF_k1:
    s_lshl_b32 s22, s19, 8
    s_add_u32 s41, s22, 0x1481000
    s_lshl_b32 s27, s31, 15
    s_lshl_b32 s22, s18, 14
    s_add_u32 s27, s27, s22
    s_add_u32 s27, s27, 0xa20000
    s_waitcnt vmcnt(0) lgkmcnt(0)
    s_cmp_eq_u32 s16, 0
    s_cbranch_scc0 K1CFf_wb
    v_min_u32 v8, 63, v1
    v_lshlrev_b32 v8, 2, v8
K1CFf_poll:
    buffer_load_dword v9, v8, s[8:11], s41 offen sc1
    s_waitcnt vmcnt(0)
    v_cmp_ne_u32 vcc, 1, v9
    s_nop 4
    s_cmp_eq_u64 vcc, 0
    s_cbranch_scc1 K1CFf_wb
    s_sleep 4
    s_branch K1CFf_poll
K1CFf_wb:
    s_barrier
    buffer_load_dwordx4 v[12:15], v2, s[8:11], s27 offen sc1
    s_add_u32 s27, s27, 1024
    buffer_load_dwordx4 v[16:19], v2, s[8:11], s27 offen sc1
    s_add_u32 s27, s27, 1024
    buffer_load_dwordx4 v[20:23], v2, s[8:11], s27 offen sc1
    s_add_u32 s27, s27, 1024
    buffer_load_dwordx4 v[24:27], v2, s[8:11], s27 offen sc1
    s_add_u32 s27, s27, 1024
    buffer_load_dwordx4 v[28:31], v2, s[8:11], s27 offen sc1
    s_add_u32 s27, s27, 1024
    buffer_load_dwordx4 v[32:35], v2, s[8:11], s27 offen sc1
    s_add_u32 s27, s27, 1024
    buffer_load_dwordx4 v[36:39], v2, s[8:11], s27 offen sc1
    s_add_u32 s27, s27, 1024
    buffer_load_dwordx4 v[40:43], v2, s[8:11], s27 offen sc1
    s_add_u32 s27, s27, 1024
    buffer_load_dwordx4 v[44:47], v2, s[8:11], s27 offen sc1
    s_add_u32 s27, s27, 1024
    buffer_load_dwordx4 v[48:51], v2, s[8:11], s27 offen sc1
    s_add_u32 s27, s27, 1024
    buffer_load_dwordx4 v[52:55], v2, s[8:11], s27 offen sc1
    s_add_u32 s27, s27, 1024
    buffer_load_dwordx4 v[56:59], v2, s[8:11], s27 offen sc1
    s_add_u32 s27, s27, 1024
    buffer_load_dwordx4 v[60:63], v2, s[8:11], s27 offen sc1
    s_add_u32 s27, s27, 1024
    buffer_load_dwordx4 v[64:67], v2, s[8:11], s27 offen sc1
    s_add_u32 s27, s27, 1024
    buffer_load_dwordx4 v[68:71], v2, s[8:11], s27 offen sc1
    s_add_u32 s27, s27, 1024
    buffer_load_dwordx4 v[72:75], v2, s[8:11], s27 offen sc1
    ds_read_b64_tr_b16 v[108:109], v124 offset:0
    ds_read_b64_tr_b16 v[110:111], v124 offset:1024
    ds_read_b64_tr_b16 v[112:113], v125 offset:0
    ds_read_b64_tr_b16 v[114:115], v125 offset:1024
    ds_read_b64_tr_b16 v[116:117], v124 offset:2048
    ds_read_b64_tr_b16 v[118:119], v124 offset:3072
    ds_read_b64_tr_b16 v[120:121], v125 offset:2048
    ds_read_b64_tr_b16 v[122:123], v125 offset:3072
    s_waitcnt vmcnt(15) lgkmcnt(4)
    v_mfma_f32_32x32x16_bf16 v[76:91], v[108:111], v[12:15], 0
    v_mfma_f32_32x32x16_bf16 v[92:107], v[112:115], v[12:15], 0
    ds_read_b64_tr_b16 v[108:109], v124 offset:4096
    ds_read_b64_tr_b16 v[110:111], v124 offset:5120
    ds_read_b64_tr_b16 v[112:113], v125 offset:4096
    ds_read_b64_tr_b16 v[114:115], v125 offset:5120
    s_waitcnt vmcnt(14) lgkmcnt(4)
    v_mfma_f32_32x32x16_bf16 v[76:91], v[116:119], v[16:19], v[76:91]
    v_mfma_f32_32x32x16_bf16 v[92:107], v[120:123], v[16:19], v[92:107]
    ds_read_b64_tr_b16 v[116:117], v124 offset:6144
    ds_read_b64_tr_b16 v[118:119], v124 offset:7168
    ds_read_b64_tr_b16 v[120:121], v125 offset:6144
    ds_read_b64_tr_b16 v[122:123], v125 offset:7168
    s_waitcnt vmcnt(13) lgkmcnt(4)
    v_mfma_f32_32x32x16_bf16 v[76:91], v[108:111], v[20:23], v[76:91]
    v_mfma_f32_32x32x16_bf16 v[92:107], v[112:115], v[20:23], v[92:107]
    ds_read_b64_tr_b16 v[108:109], v124 offset:8192
    ds_read_b64_tr_b16 v[110:111], v124 offset:9216
    ds_read_b64_tr_b16 v[112:113], v125 offset:8192
    ds_read_b64_tr_b16 v[114:115], v125 offset:9216
    s_waitcnt vmcnt(12) lgkmcnt(4)
    v_mfma_f32_32x32x16_bf16 v[76:91], v[116:119], v[24:27], v[76:91]
    v_mfma_f32_32x32x16_bf16 v[92:107], v[120:123], v[24:27], v[92:107]
    ds_read_b64_tr_b16 v[116:117], v124 offset:10240
    ds_read_b64_tr_b16 v[118:119], v124 offset:11264
    ds_read_b64_tr_b16 v[120:121], v125 offset:10240
    ds_read_b64_tr_b16 v[122:123], v125 offset:11264
    s_waitcnt vmcnt(11) lgkmcnt(4)
    v_mfma_f32_32x32x16_bf16 v[76:91], v[108:111], v[28:31], v[76:91]
    v_mfma_f32_32x32x16_bf16 v[92:107], v[112:115], v[28:31], v[92:107]
    ds_read_b64_tr_b16 v[108:109], v124 offset:12288
    ds_read_b64_tr_b16 v[110:111], v124 offset:13312
    ds_read_b64_tr_b16 v[112:113], v125 offset:12288
    ds_read_b64_tr_b16 v[114:115], v125 offset:13312
    s_waitcnt vmcnt(10) lgkmcnt(4)
    v_mfma_f32_32x32x16_bf16 v[76:91], v[116:119], v[32:35], v[76:91]
    v_mfma_f32_32x32x16_bf16 v[92:107], v[120:123], v[32:35], v[92:107]
    ds_read_b64_tr_b16 v[116:117], v124 offset:14336
    ds_read_b64_tr_b16 v[118:119], v124 offset:15360
    ds_read_b64_tr_b16 v[120:121], v125 offset:14336
    ds_read_b64_tr_b16 v[122:123], v125 offset:15360
    s_waitcnt vmcnt(9) lgkmcnt(4)
    v_mfma_f32_32x32x16_bf16 v[76:91], v[108:111], v[36:39], v[76:91]
    v_mfma_f32_32x32x16_bf16 v[92:107], v[112:115], v[36:39], v[92:107]
    ds_read_b64_tr_b16 v[108:109], v4 offset:0
    ds_read_b64_tr_b16 v[110:111], v4 offset:1024
    ds_read_b64_tr_b16 v[112:113], v6 offset:0
    ds_read_b64_tr_b16 v[114:115], v6 offset:1024
    s_waitcnt vmcnt(8) lgkmcnt(4)
    v_mfma_f32_32x32x16_bf16 v[76:91], v[116:119], v[40:43], v[76:91]
    v_mfma_f32_32x32x16_bf16 v[92:107], v[120:123], v[40:43], v[92:107]
    ds_read_b64_tr_b16 v[116:117], v4 offset:2048
    ds_read_b64_tr_b16 v[118:119], v4 offset:3072
    ds_read_b64_tr_b16 v[120:121], v6 offset:2048
    ds_read_b64_tr_b16 v[122:123], v6 offset:3072
    s_waitcnt vmcnt(7) lgkmcnt(4)
    v_mfma_f32_32x32x16_bf16 v[76:91], v[108:111], v[44:47], v[76:91]
    v_mfma_f32_32x32x16_bf16 v[92:107], v[112:115], v[44:47], v[92:107]
    ds_read_b64_tr_b16 v[108:109], v4 offset:4096
    ds_read_b64_tr_b16 v[110:111], v4 offset:5120
    ds_read_b64_tr_b16 v[112:113], v6 offset:4096
    ds_read_b64_tr_b16 v[114:115], v6 offset:5120
    s_waitcnt vmcnt(6) lgkmcnt(4)
    v_mfma_f32_32x32x16_bf16 v[76:91], v[116:119], v[48:51], v[76:91]
    v_mfma_f32_32x32x16_bf16 v[92:107], v[120:123], v[48:51], v[92:107]
    ds_read_b64_tr_b16 v[116:117], v4 offset:6144
    ds_read_b64_tr_b16 v[118:119], v4 offset:7168
    ds_read_b64_tr_b16 v[120:121], v6 offset:6144
    ds_read_b64_tr_b16 v[122:123], v6 offset:7168
    s_waitcnt vmcnt(5) lgkmcnt(4)
    v_mfma_f32_32x32x16_bf16 v[76:91], v[108:111], v[52:55], v[76:91]
    v_mfma_f32_32x32x16_bf16 v[92:107], v[112:115], v[52:55], v[92:107]
    ds_read_b64_tr_b16 v[108:109], v4 offset:8192
    ds_read_b64_tr_b16 v[110:111], v4 offset:9216
    ds_read_b64_tr_b16 v[112:113], v6 offset:8192
    ds_read_b64_tr_b16 v[114:115], v6 offset:9216
    s_waitcnt vmcnt(4) lgkmcnt(4)
    v_mfma_f32_32x32x16_bf16 v[76:91], v[116:119], v[56:59], v[76:91]
    v_mfma_f32_32x32x16_bf16 v[92:107], v[120:123], v[56:59], v[92:107]
    ds_read_b64_tr_b16 v[116:117], v4 offset:10240
    ds_read_b64_tr_b16 v[118:119], v4 offset:11264
    ds_read_b64_tr_b16 v[120:121], v6 offset:10240
    ds_read_b64_tr_b16 v[122:123], v6 offset:11264
    s_waitcnt vmcnt(3) lgkmcnt(4)
    v_mfma_f32_32x32x16_bf16 v[76:91], v[108:111], v[60:63], v[76:91]
    v_mfma_f32_32x32x16_bf16 v[92:107], v[112:115], v[60:63], v[92:107]
    ds_read_b64_tr_b16 v[108:109], v4 offset:12288
    ds_read_b64_tr_b16 v[110:111], v4 offset:13312
    ds_read_b64_tr_b16 v[112:113], v6 offset:12288
    ds_read_b64_tr_b16 v[114:115], v6 offset:13312
    s_waitcnt vmcnt(2) lgkmcnt(4)
    v_mfma_f32_32x32x16_bf16 v[76:91], v[116:119], v[64:67], v[76:91]
    v_mfma_f32_32x32x16_bf16 v[92:107], v[120:123], v[64:67], v[92:107]
    ds_read_b64_tr_b16 v[116:117], v4 offset:14336
    ds_read_b64_tr_b16 v[118:119], v4 offset:15360
    ds_read_b64_tr_b16 v[120:121], v6 offset:14336
    ds_read_b64_tr_b16 v[122:123], v6 offset:15360
    s_waitcnt vmcnt(1) lgkmcnt(4)
    v_mfma_f32_32x32x16_bf16 v[76:91], v[108:111], v[68:71], v[76:91]
    v_mfma_f32_32x32x16_bf16 v[92:107], v[112:115], v[68:71], v[92:107]
    s_waitcnt vmcnt(0) lgkmcnt(0)
    v_mfma_f32_32x32x16_bf16 v[76:91], v[116:119], v[72:75], v[76:91]
    v_mfma_f32_32x32x16_bf16 v[92:107], v[120:123], v[72:75], v[92:107]
    s_lshl_b32 s22, s16, 12
    s_xor_b32 s23, s22, 4096
    s_add_u32 s22, s22, 32768
    s_add_u32 s23, s23, 32768
    v_add_u32 v8, s22, v2
    v_add_u32 v9, s23, v2
    s_barrier
    s_nop 7
    s_cmp_eq_u32 s18, 0
    s_cbranch_scc0 K1CF_x1
    ds_write_b128 v8, v[92:95] offset:0
    ds_write_b128 v8, v[96:99] offset:1024
    ds_write_b128 v8, v[100:103] offset:2048
    ds_write_b128 v8, v[104:107] offset:3072
    s_waitcnt lgkmcnt(0)
    s_barrier
    ds_read_b128 v[92:95], v9 offset:0
    ds_read_b128 v[96:99], v9 offset:1024
    ds_read_b128 v[100:103], v9 offset:2048
    ds_read_b128 v[104:107], v9 offset:3072
    s_branch K1CF_x2
K1CF_x1:
    ds_write_b128 v8, v[76:79] offset:0
    ds_write_b128 v8, v[80:83] offset:1024
    ds_write_b128 v8, v[84:87] offset:2048
    ds_write_b128 v8, v[88:91] offset:3072
    s_waitcnt lgkmcnt(0)
    s_barrier
    ds_read_b128 v[76:79], v9 offset:0
    ds_read_b128 v[80:83], v9 offset:1024
    ds_read_b128 v[84:87], v9 offset:2048
    ds_read_b128 v[88:91], v9 offset:3072
K1CF_x2:
    ds_read_b128 v[12:15], v10 offset:0
    ds_read_b128 v[16:19], v10 offset:1024
    ds_read_b128 v[20:23], v10 offset:2048
    ds_read_b128 v[24:27], v10 offset:3072
    v_sub_f32 v8, 1.0, v126
    v_mov_b32 v127, v8
    s_waitcnt lgkmcnt(0)
    v_pk_add_f32 v[76:77], v[76:77], v[92:93]
    v_pk_add_f32 v[78:79], v[78:79], v[94:95]
    v_pk_add_f32 v[80:81], v[80:81], v[96:97]
    v_pk_add_f32 v[82:83], v[82:83], v[98:99]
    v_pk_add_f32 v[84:85], v[84:85], v[100:101]
    v_pk_add_f32 v[86:87], v[86:87], v[102:103]
    v_pk_add_f32 v[88:89], v[88:89], v[104:105]
    v_pk_add_f32 v[90:91], v[90:91], v[106:107]
    v_pk_mul_f32 v[12:13], v[12:13], v[126:127] op_sel:[0,1] op_sel_hi:[1,1]
    v_pk_mul_f32 v[14:15], v[14:15], v[126:127] op_sel:[0,1] op_sel_hi:[1,1]
    v_pk_mul_f32 v[16:17], v[16:17], v[126:127] op_sel:[0,1] op_sel_hi:[1,1]
    v_pk_mul_f32 v[18:19], v[18:19], v[126:127] op_sel:[0,1] op_sel_hi:[1,1]
    v_pk_mul_f32 v[20:21], v[20:21], v[126:127] op_sel:[0,1] op_sel_hi:[1,1]
    v_pk_mul_f32 v[22:23], v[22:23], v[126:127] op_sel:[0,1] op_sel_hi:[1,1]
    v_pk_mul_f32 v[24:25], v[24:25], v[126:127] op_sel:[0,1] op_sel_hi:[1,1]
    v_pk_mul_f32 v[26:27], v[26:27], v[126:127] op_sel:[0,1] op_sel_hi:[1,1]
    v_pk_fma_f32 v[12:13], v[76:77], v[126:127], v[12:13] op_sel_hi:[1,0,1]
    v_pk_fma_f32 v[14:15], v[78:79], v[126:127], v[14:15] op_sel_hi:[1,0,1]
    v_pk_fma_f32 v[16:17], v[80:81], v[126:127], v[16:17] op_sel_hi:[1,0,1]
    v_pk_fma_f32 v[18:19], v[82:83], v[126:127], v[18:19] op_sel_hi:[1,0,1]
    v_pk_fma_f32 v[20:21], v[84:85], v[126:127], v[20:21] op_sel_hi:[1,0,1]
    v_pk_fma_f32 v[22:23], v[86:87], v[126:127], v[22:23] op_sel_hi:[1,0,1]
    v_pk_fma_f32 v[24:25], v[88:89], v[126:127], v[24:25] op_sel_hi:[1,0,1]
    v_pk_fma_f32 v[26:27], v[90:91], v[126:127], v[26:27] op_sel_hi:[1,0,1]
    v_cvt_pk_bf16_f32 v32, v12, v13
    v_cvt_pk_bf16_f32 v33, v14, v15
    v_cvt_pk_bf16_f32 v34, v16, v17
    v_cvt_pk_bf16_f32 v35, v18, v19
    v_cvt_pk_bf16_f32 v36, v20, v21
    v_cvt_pk_bf16_f32 v37, v22, v23
    v_cvt_pk_bf16_f32 v38, v24, v25
    v_cvt_pk_bf16_f32 v39, v26, v27
    s_nop 1
    v_permlane32_swap_b32 v32, v34
    v_permlane32_swap_b32 v33, v35
    v_permlane32_swap_b32 v36, v38
    v_permlane32_swap_b32 v37, v39
    v_and_b32 v8, 31, v1
    v_lshlrev_b32 v8, 10, v8
    v_lshrrev_b32 v9, 5, v1
    v_lshl_add_u32 v8, v9, 4, v8
    s_lshl_b32 s22, s31, 15
    s_lshl_b32 s23, s32, 5
    s_add_u32 s22, s22, s23
    buffer_store_dwordx4 v[32:35], v8, s[52:55], s22 offen
    buffer_store_dwordx4 v[36:39], v8, s[52:55], s22 offen offset:32
K1C_exit:
    s_endpgm
K1_att:
    s_sub_u32 s3, s2, 256
    s_setprio 1
    s_load_dwordx2 s[4:5], s[0:1], 88
    v_lshrrev_b32 v7, 6, v0
    v_and_b32 v8, 63, v0
    v_readfirstlane_b32 s12, v7
    v_lshlrev_b32 v1, 4, v8
    s_and_b32 s22, s3, 7
    s_lshr_b32 s14, s3, 3
    s_and_b32 s13, s14, 3
    s_lshl_b32 s22, s22, 2
    s_add_u32 s13, s13, s22
    s_lshr_b32 s14, s14, 2
    s_and_b32 s28, s12, 3
    s_lshr_b32 s27, s12, 2
    s_lshl_b32 s14, s14, 3
    s_lshl_b32 s22, s28, 1
    s_add_u32 s14, s14, s22
    s_lshl_b32 s22, s13, 16
    s_lshl_b32 s23, s14, 10
    s_add_u32 s23, s23, s22
    s_lshl_b32 s26, s27, 15
    s_add_u32 s22, s22, s26
    s_add_u32 s25, s22, 0x200000
    s_add_u32 s26, s22, 0x400000
    s_add_u32 s24, s14, s27
    s_lshl_b32 s24, s24, 15
    s_lshl_b32 s22, s13, 10
    s_add_u32 s24, s24, s22
    s_add_u32 s24, s24, 0xa20000
    s_lshl_b32 s22, s28, 10
    s_add_u32 s15, s25, s22
    s_add_u32 s16, s26, s22
    s_lshl_b32 s29, s27, 13
    s_add_u32 s29, s29, s22
    s_mov_b32 s20, 0xffff
    s_mov_b32 s21, 0xffff
    s_waitcnt lgkmcnt(0)
    s_mov_b32 s8, s4
    s_mov_b32 s9, s5
    s_mov_b32 s10, 0x1600000
    s_mov_b32 s11, 0x20000
    s_load_dwordx2 s[32:33], s[0:1], 56
    s_load_dwordx2 s[34:35], s[0:1], 16
    s_lshr_b32 s22, s3, 3
    s_lshl_b32 s22, s22, 3
    s_add_u32 s22, s22, s12
    s_lshl_b32 s36, s22, 10
    s_mov_b32 s38, 4096
    s_mov_b32 s64, s4
    s_mov_b32 s65, s5
    s_mov_b32 s66, 0x1600000
    s_mov_b32 s67, 0x20000
    buffer_load_dwordx4 v[12:15], v1, s[8:11], s23 offen
    buffer_load_dwordx4 v[16:19], v1, s[8:11], s23 offen offset:1024
    s_mov_b32 s18, 0
    s_add_u32 m0, s18, s29
    s_nop 0
    buffer_load_dwordx4 v1, s[8:11], s15 offen lds
    s_add_u32 m0, m0, 4096
    s_add_u32 s15, s15, 4096
    buffer_load_dwordx4 v1, s[8:11], s16 offen lds
    s_add_u32 s16, s16, 4096
    s_mov_b32 s18, 16384
    s_add_u32 m0, s18, s29
    s_nop 0
    buffer_load_dwordx4 v1, s[8:11], s15 offen lds
    s_add_u32 m0, m0, 4096
    s_add_u32 s15, s15, 4096
    buffer_load_dwordx4 v1, s[8:11], s16 offen lds
    s_add_u32 s16, s16, 4096
    s_mov_b32 s18, 32768
    s_add_u32 m0, s18, s29
    s_nop 0
    buffer_load_dwordx4 v1, s[8:11], s15 offen lds
    s_add_u32 m0, m0, 4096
    s_add_u32 s15, s15, 4096
    buffer_load_dwordx4 v1, s[8:11], s16 offen lds
    s_add_u32 s16, s16, 4096
    s_mov_b32 s18, 49152
    s_add_u32 m0, s18, s29
    s_nop 0
    buffer_load_dwordx4 v1, s[8:11], s15 offen lds
    s_add_u32 m0, m0, 4096
    s_add_u32 s15, s15, 4096
    buffer_load_dwordx4 v1, s[8:11], s16 offen lds
    s_add_u32 s16, s16, 4096
    s_mov_b32 s18, 65536
    s_mov_b32 s17, 16384
    s_mov_b32 s19, 0
    s_mov_b32 s40, 0
    s_lshl_b32 s22, s27, 13
    v_add_u32 v4, s22, v1
    v_mov_b32 v2, v4
    v_lshrrev_b32 v7, 5, v8
    v_and_b32 v9, 15, v8
    v_lshlrev_b32 v7, 8, v7
    v_lshlrev_b32 v9, 4, v9
    v_add_u32 v5, v7, v9
    v_add_u32 v5, s22, v5
    v_add_u32 v5, 4096, v5
    v_mov_b32 v3, v5
    v_mov_b32 v6, 0xdddddddd
    v_and_b32 v7, 27, v8
    v_cmp_eq_u32 vcc, 16, v7
    v_mov_b32 v9, 0x3f803f80
    s_nop 0
    v_cndmask_b32 v7, 0, v9, vcc
    v_mov_b32 v24, v7
    v_mov_b32 v28, v7
    v_mov_b32 v32, v7
    v_mov_b32 v25, v7
    v_mov_b32 v29, v7
    v_mov_b32 v33, v7
    v_mov_b32 v26, v7
    v_mov_b32 v30, v7
    v_mov_b32 v34, v7
    v_mov_b32 v27, v7
    v_mov_b32 v31, v7
    v_mov_b32 v35, v7
    v_mov_b32 v68, 0
    v_mov_b32 v84, 0
    v_mov_b32 v69, 0
    v_mov_b32 v85, 0
    v_mov_b32 v70, 0
    v_mov_b32 v86, 0
    v_mov_b32 v71, 0
    v_mov_b32 v87, 0
    v_mov_b32 v72, 0
    v_mov_b32 v88, 0
    v_mov_b32 v73, 0
    v_mov_b32 v89, 0
    v_mov_b32 v74, 0
    v_mov_b32 v90, 0
    v_mov_b32 v75, 0
    v_mov_b32 v91, 0
    v_mov_b32 v76, 0
    v_mov_b32 v92, 0
    v_mov_b32 v77, 0
    v_mov_b32 v93, 0
    v_mov_b32 v78, 0
    v_mov_b32 v94, 0
    v_mov_b32 v79, 0
    v_mov_b32 v95, 0
    v_mov_b32 v80, 0
    v_mov_b32 v96, 0
    v_mov_b32 v81, 0
    v_mov_b32 v97, 0
    v_mov_b32 v82, 0
    v_mov_b32 v98, 0
    v_mov_b32 v83, 0
    v_mov_b32 v99, 0
    v_mov_b32 v10, 0
    v_mov_b32 v11, 0
    v_mov_b32 v52, 0
    v_mov_b32 v53, 0
    v_mov_b32 v54, 0
    v_mov_b32 v55, 0
    v_mov_b32 v56, 0
    v_mov_b32 v57, 0
    v_mov_b32 v58, 0
    v_mov_b32 v59, 0
    v_mov_b32 v60, 0
    v_mov_b32 v61, 0
    v_mov_b32 v62, 0
    v_mov_b32 v63, 0
    v_mov_b32 v64, 0
    v_mov_b32 v65, 0
    v_mov_b32 v66, 0
    v_mov_b32 v67, 0
    s_waitcnt lgkmcnt(0)
    s_mov_b32 s56, s32
    s_mov_b32 s57, s33
    s_mov_b32 s58, 0x0
    s_mov_b32 s59, 0x20000
    s_mov_b32 s60, s34
    s_mov_b32 s61, s35
    s_mov_b32 s62, 0x0
    s_mov_b32 s63, 0x20000
    s_waitcnt vmcnt(6)
    s_barrier
    ds_read_b128 v[20:23], v2
    s_waitcnt lgkmcnt(0)
    v_mfma_f32_32x32x16_bf16 v[36:51], v[20:23], v[12:15], 0
    s_mov_b64 exec, s[20:21]
    ds_read_b128 v[24:27], v3
    ds_read_b128 v[28:31], v3 offset:512
    s_mov_b64 exec, -1
    s_setprio 0
    s_nop 15
.p2align 6
K1A_loop:
    v_exp_f32 v36, v36
    v_exp_f32 v37, v37
    v_smfmac_f32_32x32x32_bf16 v[84:99], v[32:35], v[60:67], v6
    v_exp_f32 v38, v38
    v_exp_f32 v39, v39
    v_exp_f32 v40, v40
    v_mfma_f32_32x32x16_bf16 v[52:67], v[20:23], v[16:19], 0
    ds_read_b128 v[20:23], v2 offset:1024
    v_exp_f32 v41, v41
    v_exp_f32 v42, v42
    v_exp_f32 v43, v43
    v_exp_f32 v44, v44
    v_exp_f32 v45, v45
    s_waitcnt lgkmcnt(2)
    v_smfmac_f32_32x32x32_bf16 v[68:83], v[24:27], v[36:43], v6
    v_exp_f32 v46, v46
    v_exp_f32 v47, v47
    v_exp_f32 v48, v48
    v_exp_f32 v49, v49
    v_exp_f32 v50, v50
    v_exp_f32 v51, v51
    v_exp_f32 v52, v52
    v_exp_f32 v53, v53
    s_waitcnt lgkmcnt(0)
    v_smfmac_f32_32x32x32_bf16 v[68:83], v[28:31], v[44:51], v6
    v_exp_f32 v54, v54
    v_exp_f32 v55, v55
    v_exp_f32 v56, v56
    v_mfma_f32_32x32x16_bf16 v[36:51], v[20:23], v[12:15], 0
    v_exp_f32 v57, v57
    v_exp_f32 v58, v58
    v_exp_f32 v59, v59
    v_exp_f32 v60, v60
    v_exp_f32 v61, v61
    v_smfmac_f32_32x32x32_bf16 v[84:99], v[24:27], v[52:59], v6
    s_mov_b64 exec, s[20:21]
    ds_read_b128 v[24:27], v3 offset:1024
    ds_read_b128 v[32:35], v3 offset:1536
    s_mov_b64 exec, -1
    v_exp_f32 v62, v62
    v_exp_f32 v63, v63
    v_exp_f32 v64, v64
    v_exp_f32 v65, v65
    v_exp_f32 v66, v66
    v_exp_f32 v67, v67
    v_exp_f32 v36, v36
    v_exp_f32 v37, v37
    v_smfmac_f32_32x32x32_bf16 v[84:99], v[28:31], v[60:67], v6
    v_exp_f32 v38, v38
    v_exp_f32 v39, v39
    v_exp_f32 v40, v40
    v_mfma_f32_32x32x16_bf16 v[52:67], v[20:23], v[16:19], 0
    ds_read_b128 v[20:23], v2 offset:2048
    v_exp_f32 v41, v41
    v_exp_f32 v42, v42
    v_exp_f32 v43, v43
    v_exp_f32 v44, v44
    v_exp_f32 v45, v45
    s_waitcnt lgkmcnt(2)
    v_smfmac_f32_32x32x32_bf16 v[68:83], v[24:27], v[36:43], v6
    v_exp_f32 v46, v46
    v_exp_f32 v47, v47
    v_exp_f32 v48, v48
    v_exp_f32 v49, v49
    v_exp_f32 v50, v50
    v_exp_f32 v51, v51
    v_exp_f32 v52, v52
    v_exp_f32 v53, v53
    s_waitcnt lgkmcnt(0)
    v_smfmac_f32_32x32x32_bf16 v[68:83], v[32:35], v[44:51], v6
    v_exp_f32 v54, v54
    v_exp_f32 v55, v55
    v_exp_f32 v56, v56
    v_mfma_f32_32x32x16_bf16 v[36:51], v[20:23], v[12:15], 0
    v_exp_f32 v57, v57
    v_exp_f32 v58, v58
    v_exp_f32 v59, v59
    v_exp_f32 v60, v60
    v_exp_f32 v61, v61
    v_smfmac_f32_32x32x32_bf16 v[84:99], v[24:27], v[52:59], v6
    s_mov_b64 exec, s[20:21]
    ds_read_b128 v[24:27], v3 offset:2048
    ds_read_b128 v[28:31], v3 offset:2560
    s_mov_b64 exec, -1
    v_exp_f32 v62, v62
    v_exp_f32 v63, v63
    v_exp_f32 v64, v64
    v_exp_f32 v65, v65
    v_exp_f32 v66, v66
    v_exp_f32 v67, v67
    v_exp_f32 v36, v36
    v_exp_f32 v37, v37
    v_smfmac_f32_32x32x32_bf16 v[84:99], v[32:35], v[60:67], v6
    v_exp_f32 v38, v38
    v_exp_f32 v39, v39
    v_exp_f32 v40, v40
    v_mfma_f32_32x32x16_bf16 v[52:67], v[20:23], v[16:19], 0
    ds_read_b128 v[20:23], v2 offset:3072
    v_exp_f32 v41, v41
    v_exp_f32 v42, v42
    v_exp_f32 v43, v43
    v_exp_f32 v44, v44
    v_exp_f32 v45, v45
    s_waitcnt lgkmcnt(2)
    v_smfmac_f32_32x32x32_bf16 v[68:83], v[24:27], v[36:43], v6
    v_exp_f32 v46, v46
    v_exp_f32 v47, v47
    v_exp_f32 v48, v48
    v_exp_f32 v49, v49
    v_exp_f32 v50, v50
    v_exp_f32 v51, v51
    v_exp_f32 v52, v52
    v_exp_f32 v53, v53
    s_waitcnt lgkmcnt(0)
    v_smfmac_f32_32x32x32_bf16 v[68:83], v[28:31], v[44:51], v6
    v_exp_f32 v54, v54
    v_exp_f32 v55, v55
    v_exp_f32 v56, v56
    v_mfma_f32_32x32x16_bf16 v[36:51], v[20:23], v[12:15], 0
    v_exp_f32 v57, v57
    v_exp_f32 v58, v58
    v_exp_f32 v59, v59
    v_exp_f32 v60, v60
    v_exp_f32 v61, v61
    v_smfmac_f32_32x32x32_bf16 v[84:99], v[24:27], v[52:59], v6
    s_mov_b64 exec, s[20:21]
    ds_read_b128 v[24:27], v3 offset:3072
    ds_read_b128 v[32:35], v3 offset:3584
    s_mov_b64 exec, -1
    v_exp_f32 v62, v62
    v_exp_f32 v63, v63
    v_exp_f32 v64, v64
    v_exp_f32 v65, v65
    v_exp_f32 v66, v66
    v_exp_f32 v67, v67
    v_exp_f32 v36, v36
    v_exp_f32 v37, v37
    v_smfmac_f32_32x32x32_bf16 v[84:99], v[28:31], v[60:67], v6
    v_exp_f32 v38, v38
    v_exp_f32 v39, v39
    v_exp_f32 v40, v40
    v_mfma_f32_32x32x16_bf16 v[52:67], v[20:23], v[16:19], 0
    s_waitcnt vmcnt(4)
    s_barrier
    v_add_u32 v2, s17, v4
    ds_read_b128 v[20:23], v2 offset:0
    v_exp_f32 v41, v41
    v_exp_f32 v42, v42
    v_exp_f32 v43, v43
    v_exp_f32 v44, v44
    v_exp_f32 v45, v45
    s_waitcnt lgkmcnt(2)
    v_smfmac_f32_32x32x32_bf16 v[68:83], v[24:27], v[36:43], v6
    s_add_u32 m0, s18, s29
    s_nop 0
    buffer_load_dwordx4 v1, s[64:67], s15 offen lds
    s_add_u32 m0, m0, 4096
    s_add_u32 s15, s15, s38
    buffer_load_dwordx4 v1, s[64:67], s16 offen lds
    s_add_u32 s16, s16, s38
    v_exp_f32 v46, v46
    v_exp_f32 v47, v47
    v_exp_f32 v48, v48
    v_exp_f32 v49, v49
    v_exp_f32 v50, v50
    v_exp_f32 v51, v51
    v_exp_f32 v52, v52
    v_exp_f32 v53, v53
    s_waitcnt lgkmcnt(0)
    v_smfmac_f32_32x32x32_bf16 v[68:83], v[32:35], v[44:51], v6
    v_exp_f32 v54, v54
    v_exp_f32 v55, v55
    v_exp_f32 v56, v56
    v_mfma_f32_32x32x16_bf16 v[36:51], v[20:23], v[12:15], 0
    v_exp_f32 v57, v57
    v_exp_f32 v58, v58
    v_exp_f32 v59, v59
    v_exp_f32 v60, v60
    v_exp_f32 v61, v61
    v_smfmac_f32_32x32x32_bf16 v[84:99], v[24:27], v[52:59], v6
    v_add_u32 v3, s17, v5
    s_mov_b64 exec, s[20:21]
    ds_read_b128 v[24:27], v3 offset:0
    ds_read_b128 v[28:31], v3 offset:512
    s_mov_b64 exec, -1
    v_exp_f32 v62, v62
    v_exp_f32 v63, v63
    v_exp_f32 v64, v64
    v_exp_f32 v65, v65
    v_exp_f32 v66, v66
    v_exp_f32 v67, v67
    s_mov_b32 s40, s17
    s_add_u32 s17, s17, 16384
    s_cmp_eq_u32 s17, 81920
    s_cselect_b32 s17, 0, s17
    s_add_u32 s18, s18, 16384
    s_cmp_eq_u32 s18, 81920
    s_cselect_b32 s18, 0, s18
    s_add_u32 s19, s19, 1
    s_cmp_eq_u32 s19, 4
    s_cbranch_scc0 K1A_nsw1
    s_mov_b32 s64, s56
    s_mov_b32 s65, s57
    s_mov_b32 s66, s58
    s_mov_b32 s15, s36
    s_add_u32 s16, s36, 0x40000
    s_mov_b32 s38, 0x80000
K1A_nsw1:
    s_cmp_eq_u32 s19, 7
    s_cbranch_scc0 K1A_nsw2
    s_mov_b32 s64, s60
    s_mov_b32 s65, s61
    s_mov_b32 s66, s62
    s_mov_b32 s15, s36
    s_add_u32 s16, s36, 0x40000
K1A_nsw2:
    s_cmp_lt_u32 s19, 8
    s_cbranch_scc1 K1A_loop
    s_nop 1
    v_smfmac_f32_32x32x32_bf16 v[84:99], v[32:35], v[60:67], v6
    s_waitcnt lgkmcnt(0)
    s_nop 15
    v_add_f32 v7, abs(v76), abs(v92)
    v_add_f32 v7, abs(v68), v7
    v_add_f32 v7, abs(v69), v7
    v_add_f32 v7, abs(v70), v7
    v_add_f32 v7, abs(v71), v7
    v_add_f32 v7, abs(v72), v7
    v_add_f32 v7, abs(v73), v7
    v_add_f32 v7, abs(v74), v7
    v_add_f32 v7, abs(v75), v7
    v_add_f32 v7, abs(v84), v7
    v_add_f32 v7, abs(v85), v7
    v_add_f32 v7, abs(v86), v7
    v_add_f32 v7, abs(v87), v7
    v_add_f32 v7, abs(v88), v7
    v_add_f32 v7, abs(v89), v7
    v_add_f32 v7, abs(v90), v7
    v_add_f32 v7, abs(v91), v7
    v_min_f32 v8, v76, v92
    s_mov_b32 s22, 0x207
    v_cmp_class_f32 vcc, v7, s22
    s_mov_b32 s22, 0x2b800000
    v_cmp_gt_f32 s[30:31], s22, v8
    s_nop 4
    s_or_b64 vcc, vcc, s[30:31]
    s_cmp_lg_u64 vcc, 0
    s_cbranch_scc1 K1A_fallback
K1A_merge:
    s_barrier
    s_mul_i32 s22, s12, 2560
    s_add_u32 s22, s22, 32768
    v_add_u32 v2, s22, v1
    s_xor_b32 s19, s12, 4
    s_mul_i32 s19, s19, 2560
    s_add_u32 s19, s19, 32768
    v_add_u32 v3, s19, v1
    v_lshrrev_b32 v9, 1, v1
    v_add_u32 v4, s22, v9
    v_add_u32 v5, s19, v9
    s_cmp_eq_u32 s27, 0
    s_cbranch_scc0 K1A_m1
    v_mov_b32 v93, v11
    ds_write_b128 v2, v[84:87]
    ds_write_b128 v2, v[88:91] offset:1024
    ds_write_b64 v4, v[92:93] offset:2048
    s_waitcnt lgkmcnt(0)
    s_barrier
    ds_read_b128 v[84:87], v3
    ds_read_b128 v[88:91], v3 offset:1024
    ds_read_b64 v[92:93], v5 offset:2048
    s_waitcnt lgkmcnt(0)
    v_max_f32 v7, v10, v93
    v_sub_f32 v8, v10, v7
    v_sub_f32 v9, v93, v7
    v_exp_f32 v8, v8
    v_exp_f32 v9, v9
    s_nop 0
    v_mul_f32 v76, v76, v8
    v_fmac_f32 v76, v92, v9
    v_rcp_f32 v7, v76
    s_nop 0
    v_mul_f32 v8, v8, v7
    v_mul_f32 v9, v9, v7
    v_mul_f32 v68, v68, v8
    v_fmac_f32 v68, v84, v9
    v_mul_f32 v69, v69, v8
    v_fmac_f32 v69, v85, v9
    v_mul_f32 v70, v70, v8
    v_fmac_f32 v70, v86, v9
    v_mul_f32 v71, v71, v8
    v_fmac_f32 v71, v87, v9
    v_mul_f32 v72, v72, v8
    v_fmac_f32 v72, v88, v9
    v_mul_f32 v73, v73, v8
    v_fmac_f32 v73, v89, v9
    v_mul_f32 v74, v74, v8
    v_fmac_f32 v74, v90, v9
    v_mul_f32 v75, v75, v8
    v_fmac_f32 v75, v91, v9
    v_cvt_pk_bf16_f32 v20, v68, v69
    v_cvt_pk_bf16_f32 v21, v70, v71
    v_cvt_pk_bf16_f32 v22, v72, v73
    v_cvt_pk_bf16_f32 v23, v74, v75
    s_branch K1A_store
K1A_m1:
    v_mov_b32 v77, v10
    ds_write_b128 v2, v[68:71]
    ds_write_b128 v2, v[72:75] offset:1024
    ds_write_b64 v4, v[76:77] offset:2048
    s_waitcnt lgkmcnt(0)
    s_barrier
    ds_read_b128 v[68:71], v3
    ds_read_b128 v[72:75], v3 offset:1024
    ds_read_b64 v[76:77], v5 offset:2048
    s_waitcnt lgkmcnt(0)
    v_max_f32 v7, v11, v77
    v_sub_f32 v8, v11, v7
    v_sub_f32 v9, v77, v7
    v_exp_f32 v8, v8
    v_exp_f32 v9, v9
    s_nop 0
    v_mul_f32 v92, v92, v8
    v_fmac_f32 v92, v76, v9
    v_rcp_f32 v7, v92
    s_nop 0
    v_mul_f32 v8, v8, v7
    v_mul_f32 v9, v9, v7
    v_mul_f32 v84, v84, v8
    v_fmac_f32 v84, v68, v9
    v_mul_f32 v85, v85, v8
    v_fmac_f32 v85, v69, v9
    v_mul_f32 v86, v86, v8
    v_fmac_f32 v86, v70, v9
    v_mul_f32 v87, v87, v8
    v_fmac_f32 v87, v71, v9
    v_mul_f32 v88, v88, v8
    v_fmac_f32 v88, v72, v9
    v_mul_f32 v89, v89, v8
    v_fmac_f32 v89, v73, v9
    v_mul_f32 v90, v90, v8
    v_fmac_f32 v90, v74, v9
    v_mul_f32 v91, v91, v8
    v_fmac_f32 v91, v75, v9
    v_cvt_pk_bf16_f32 v20, v84, v85
    v_cvt_pk_bf16_f32 v21, v86, v87
    v_cvt_pk_bf16_f32 v22, v88, v89
    v_cvt_pk_bf16_f32 v23, v90, v91
    s_branch K1A_store
K1A_store:
    buffer_store_dwordx4 v[20:23], v1, s[8:11], s24 offen sc1
    s_add_u32 s22, s14, s27
    s_lshl_b32 s22, s22, 5
    s_add_u32 s22, s22, s13
    s_lshl_b32 s22, s22, 2
    s_add_u32 s22, s22, 0x1481000
    v_mov_b32 v7, 1
    v_mov_b32 v8, 0
    s_waitcnt vmcnt(0)
    s_mov_b64 exec, 1
    buffer_store_dword v7, v8, s[8:11], s22 offen sc1
    s_mov_b64 exec, -1
    s_endpgm
K1A_fallback:
    s_lshl_b32 s22, s27, 13
    v_subrev_u32 v3, s22, v5
    v_subrev_u32 v3, 4096, v3
    v_mov_b32 v7, 0xff800000
    s_mov_b32 s19, 0
    s_mov_b32 s15, s25
K1A_fb1_0:
    buffer_load_dwordx4 v[20:23], v1, s[8:11], s15 offen
    s_waitcnt vmcnt(0)
    v_mfma_f32_32x32x16_bf16 v[36:51], v[20:23], v[12:15], 0
    s_nop 15
    v_max3_f32 v7, v7, v36, v37
    v_max3_f32 v7, v7, v38, v39
    v_max3_f32 v7, v7, v40, v41
    v_max3_f32 v7, v7, v42, v43
    v_max3_f32 v7, v7, v44, v45
    v_max3_f32 v7, v7, v46, v47
    v_max3_f32 v7, v7, v48, v49
    v_max3_f32 v7, v7, v50, v51
    s_add_u32 s15, s15, 1024
    s_add_u32 s19, s19, 1
    s_cmp_lt_u32 s19, 32
    s_cbranch_scc1 K1A_fb1_0
    v_mov_b32 v8, v7
    s_nop 1
    v_permlane32_swap_b32 v7, v8
    s_nop 1
    v_max_f32 v10, v7, v8
    v_mul_f32 v100, -1.0, v10
    v_mul_f32 v101, -1.0, v10
    v_mul_f32 v102, -1.0, v10
    v_mul_f32 v103, -1.0, v10
    v_mul_f32 v104, -1.0, v10
    v_mul_f32 v105, -1.0, v10
    v_mul_f32 v106, -1.0, v10
    v_mul_f32 v107, -1.0, v10
    v_mul_f32 v108, -1.0, v10
    v_mul_f32 v109, -1.0, v10
    v_mul_f32 v110, -1.0, v10
    v_mul_f32 v111, -1.0, v10
    v_mul_f32 v112, -1.0, v10
    v_mul_f32 v113, -1.0, v10
    v_mul_f32 v114, -1.0, v10
    v_mul_f32 v115, -1.0, v10
    v_mov_b32 v68, 0
    v_mov_b32 v69, 0
    v_mov_b32 v70, 0
    v_mov_b32 v71, 0
    v_mov_b32 v72, 0
    v_mov_b32 v73, 0
    v_mov_b32 v74, 0
    v_mov_b32 v75, 0
    v_mov_b32 v76, 0
    v_mov_b32 v77, 0
    v_mov_b32 v78, 0
    v_mov_b32 v79, 0
    v_mov_b32 v80, 0
    v_mov_b32 v81, 0
    v_mov_b32 v82, 0
    v_mov_b32 v83, 0
    s_mov_b32 s19, 0
    s_mov_b32 s15, s25
    s_mov_b32 s16, s26
K1A_fb2_0:
    buffer_load_dwordx4 v[20:23], v1, s[8:11], s15 offen
    s_mov_b64 exec, s[20:21]
    buffer_load_dwordx4 v[24:27], v3, s[8:11], s16 offen
    buffer_load_dwordx4 v[28:31], v3, s[8:11], s16 offen offset:512
    s_mov_b64 exec, -1
    s_waitcnt vmcnt(0)
    v_mfma_f32_32x32x16_bf16 v[36:51], v[20:23], v[12:15], v[100:115]
    s_nop 15
    v_exp_f32 v36, v36
    v_exp_f32 v37, v37
    v_exp_f32 v38, v38
    v_exp_f32 v39, v39
    v_exp_f32 v40, v40
    v_exp_f32 v41, v41
    v_exp_f32 v42, v42
    v_exp_f32 v43, v43
    v_exp_f32 v44, v44
    v_exp_f32 v45, v45
    v_exp_f32 v46, v46
    v_exp_f32 v47, v47
    v_exp_f32 v48, v48
    v_exp_f32 v49, v49
    v_exp_f32 v50, v50
    v_exp_f32 v51, v51
    s_nop 3
    v_smfmac_f32_32x32x32_bf16 v[68:83], v[24:27], v[36:43], v6
    v_smfmac_f32_32x32x32_bf16 v[68:83], v[28:31], v[44:51], v6
    s_add_u32 s15, s15, 1024
    s_add_u32 s16, s16, 1024
    s_add_u32 s19, s19, 1
    s_cmp_lt_u32 s19, 32
    s_cbranch_scc1 K1A_fb2_0
    v_mov_b32 v7, 0xff800000
    s_mov_b32 s19, 0
    s_mov_b32 s15, s25
K1A_fb1_1:
    buffer_load_dwordx4 v[20:23], v1, s[8:11], s15 offen
    s_waitcnt vmcnt(0)
    v_mfma_f32_32x32x16_bf16 v[36:51], v[20:23], v[16:19], 0
    s_nop 15
    v_max3_f32 v7, v7, v36, v37
    v_max3_f32 v7, v7, v38, v39
    v_max3_f32 v7, v7, v40, v41
    v_max3_f32 v7, v7, v42, v43
    v_max3_f32 v7, v7, v44, v45
    v_max3_f32 v7, v7, v46, v47
    v_max3_f32 v7, v7, v48, v49
    v_max3_f32 v7, v7, v50, v51
    s_add_u32 s15, s15, 1024
    s_add_u32 s19, s19, 1
    s_cmp_lt_u32 s19, 32
    s_cbranch_scc1 K1A_fb1_1
    v_mov_b32 v8, v7
    s_nop 1
    v_permlane32_swap_b32 v7, v8
    s_nop 1
    v_max_f32 v11, v7, v8
    v_mul_f32 v100, -1.0, v11
    v_mul_f32 v101, -1.0, v11
    v_mul_f32 v102, -1.0, v11
    v_mul_f32 v103, -1.0, v11
    v_mul_f32 v104, -1.0, v11
    v_mul_f32 v105, -1.0, v11
    v_mul_f32 v106, -1.0, v11
    v_mul_f32 v107, -1.0, v11
    v_mul_f32 v108, -1.0, v11
    v_mul_f32 v109, -1.0, v11
    v_mul_f32 v110, -1.0, v11
    v_mul_f32 v111, -1.0, v11
    v_mul_f32 v112, -1.0, v11
    v_mul_f32 v113, -1.0, v11
    v_mul_f32 v114, -1.0, v11
    v_mul_f32 v115, -1.0, v11
    v_mov_b32 v84, 0
    v_mov_b32 v85, 0
    v_mov_b32 v86, 0
    v_mov_b32 v87, 0
    v_mov_b32 v88, 0
    v_mov_b32 v89, 0
    v_mov_b32 v90, 0
    v_mov_b32 v91, 0
    v_mov_b32 v92, 0
    v_mov_b32 v93, 0
    v_mov_b32 v94, 0
    v_mov_b32 v95, 0
    v_mov_b32 v96, 0
    v_mov_b32 v97, 0
    v_mov_b32 v98, 0
    v_mov_b32 v99, 0
    s_mov_b32 s19, 0
    s_mov_b32 s15, s25
    s_mov_b32 s16, s26
K1A_fb2_1:
    buffer_load_dwordx4 v[20:23], v1, s[8:11], s15 offen
    s_mov_b64 exec, s[20:21]
    buffer_load_dwordx4 v[24:27], v3, s[8:11], s16 offen
    buffer_load_dwordx4 v[28:31], v3, s[8:11], s16 offen offset:512
    s_mov_b64 exec, -1
    s_waitcnt vmcnt(0)
    v_mfma_f32_32x32x16_bf16 v[36:51], v[20:23], v[16:19], v[100:115]
    s_nop 15
    v_exp_f32 v36, v36
    v_exp_f32 v37, v37
    v_exp_f32 v38, v38
    v_exp_f32 v39, v39
    v_exp_f32 v40, v40
    v_exp_f32 v41, v41
    v_exp_f32 v42, v42
    v_exp_f32 v43, v43
    v_exp_f32 v44, v44
    v_exp_f32 v45, v45
    v_exp_f32 v46, v46
    v_exp_f32 v47, v47
    v_exp_f32 v48, v48
    v_exp_f32 v49, v49
    v_exp_f32 v50, v50
    v_exp_f32 v51, v51
    s_nop 3
    v_smfmac_f32_32x32x32_bf16 v[84:99], v[24:27], v[36:43], v6
    v_smfmac_f32_32x32x32_bf16 v[84:99], v[28:31], v[44:51], v6
    s_add_u32 s15, s15, 1024
    s_add_u32 s16, s16, 1024
    s_add_u32 s19, s19, 1
    s_cmp_lt_u32 s19, 32
    s_cbranch_scc1 K1A_fb2_1
    s_nop 15
    s_branch K1A_merge
L_exit1:
    s_endpgm
L_text_end:
    s_endpgm
.section .rodata,"a"
.p2align 6
.amdhsa_kernel k1_kernel
  .amdhsa_next_free_vgpr 152
  .amdhsa_next_free_sgpr 96
  .amdhsa_accum_offset 152
  .amdhsa_group_segment_fixed_size 0
  .amdhsa_kernarg_size 96
  .amdhsa_user_sgpr_count 2
  .amdhsa_user_sgpr_kernarg_segment_ptr 1
  .amdhsa_system_sgpr_workgroup_id_x 1
  .amdhsa_float_denorm_mode_32 3
  .amdhsa_float_denorm_mode_16_64 3
.end_amdhsa_kernel
.amdhsa_kernel gated_mix__softmax_full_mha__mixer_s_mlp__prompt_kernel
  .amdhsa_next_free_vgpr 128
  .amdhsa_next_free_sgpr 96
  .amdhsa_accum_offset 128
  .amdhsa_group_segment_fixed_size 0
  .amdhsa_kernarg_size 96
  .amdhsa_user_sgpr_count 2
  .amdhsa_user_sgpr_kernarg_segment_ptr 1
  .amdhsa_system_sgpr_workgroup_id_x 1
  .amdhsa_float_denorm_mode_32 3
  .amdhsa_float_denorm_mode_16_64 3
.end_amdhsa_kernel
```
